```python
import torch

def _softmax(x, axis=-1):
    return torch.softmax(x, dim=axis)
def _gelu(x):
    return torch.nn.functional.gelu(x, approximate="tanh")
def _silu(x):
    return torch.nn.functional.silu(x)
def _sigmoid(x):
    return torch.sigmoid(x)
def _layernorm(x, axis=-1, eps=1e-5):
    m = x.mean(dim=axis, keepdim=True)
    v = x.var(dim=axis, keepdim=True, unbiased=False)
    return (x - m) / torch.sqrt(v + eps)
def _scatter_add(tgt, idx, src, axis=0):
    return tgt.clone().index_add_(axis, idx, src)
def _segment_sum(src, seg, n):
    out = torch.zeros((n,) + src.shape[1:], dtype=src.dtype)
    return out.index_add_(0, seg, src)
def _pad(x, pw):
    flat = tuple(v for pair in reversed(pw) for v in pair)
    return torch.nn.functional.pad(x, flat)

kernel_name = 'interleave_layers__grouped_kv_mqa__sliding_block__prompt'

def setup_inputs():

    _w = (lambda a: (lambda t: t.to(torch.bfloat16) if t.is_floating_point() else t)(torch.as_tensor(a)))
    def _A_setup():
        B, S, D, H = 1, 2048, 512, 32
        Dh = D // H
        return {
            "x": _w((lambda *s: torch.randn(*s, dtype=torch.bfloat16) * 0.05)(B, S, D)),
            "wq": _w((lambda *s: torch.randn(*s, dtype=torch.bfloat16) * 0.05)(D, H * Dh)),
            "wk": _w((lambda *s: torch.randn(*s, dtype=torch.bfloat16) * 0.05)(D, Dh)),
            "wv": _w((lambda *s: torch.randn(*s, dtype=torch.bfloat16) * 0.05)(D, Dh)),
            "wo": _w((lambda *s: torch.randn(*s, dtype=torch.bfloat16) * 0.05)(H * Dh, D)),
        }
    _A_in = _A_setup()

    def _B_setup():
        B, S, D = 1, 2048, 512
        return {
            "x": _w((lambda *s: torch.randn(*s, dtype=torch.bfloat16) * 0.05)(B, S, D)),
            "wqkv": _w((lambda *s: torch.randn(*s, dtype=torch.bfloat16) * 0.05)(D, 3 * D)),
            "wo": _w((lambda *s: torch.randn(*s, dtype=torch.bfloat16) * 0.05)(D, D)),
        }
    _B_in = _B_setup()

    return {
        "A_x": _A_in["x"],
        "A_wq": _A_in["wq"],
        "A_wk": _A_in["wk"],
        "A_wv": _A_in["wv"],
        "A_wo": _A_in["wo"],
        "B_x": _B_in["x"],
        "B_wqkv": _B_in["wqkv"],
        "B_wo": _B_in["wo"],
    }

def reference(A_x, A_wq, A_wk, A_wv, A_wo, B_x, B_wqkv, B_wo):
    def _A_ref(x, wq, wk, wv, wo):
        B, S, D = x.shape
        H = 32
        Dh = D // H
        q = (lambda x, *d: x.permute(*d))((x @ wq).reshape(B, S, H, Dh), 0, 2, 1, 3)
        k = x @ wk
        v = x @ wv
        scores = torch.einsum("bhqd,bkd->bhqk", q, k) * (Dh ** -0.5)
        p = _softmax(scores, axis=-1)
        o = torch.einsum("bhqk,bkd->bhqd", p, v)
        return (lambda x, *d: x.permute(*d))(o, 0, 2, 1, 3).reshape(B, S, H * Dh) @ wo

    def _B_ref(x, wqkv, wo):
        B, S, D = x.shape
        H = 32; Dh = D // H; W = 256
        qkv = (lambda x, *d: x.permute(*d))((x @ wqkv).reshape(B, S, 3, H, Dh), 2, 0, 3, 1, 4)
        q, k, v = qkv[0], qkv[1], qkv[2]
        scores = torch.einsum("bhqd,bhkd->bhqk", q, k) * (Dh ** -0.5)
        idx = torch.arange(S)
        mask = (idx[:, None] - idx[None, :] >= 0) & (idx[:, None] - idx[None, :] < W)
        scores = torch.where(mask[None, None], scores, -1e9)
        p = _softmax(scores, axis=-1)
        o = torch.einsum("bhqk,bhkd->bhqd", p, v)
        return (lambda x, *d: x.permute(*d))(o, 0, 2, 1, 3).reshape(B, S, D) @ wo

    x = A_x
    x = x + _A_ref(_layernorm(x, axis=-1), A_wq, A_wk, A_wv, A_wo)
    x = x + _B_ref(_layernorm(x, axis=-1), B_wqkv, B_wo)
    x = x + _A_ref(_layernorm(x, axis=-1), A_wq, A_wk, A_wv, A_wo)
    x = x + _B_ref(_layernorm(x, axis=-1), B_wqkv, B_wo)
    return x
```

```asm
; @launch grid=(256,1,1) block=(512,1,1) lds=163840
.amdgcn_target "amdgcn-amd-amdhsa--gfx950"
.text
.globl interleave_layers__grouped_kv_mqa__sliding_block__prompt_kernel
.p2align 8
.type interleave_layers__grouped_kv_mqa__sliding_block__prompt_kernel,@function
interleave_layers__grouped_kv_mqa__sliding_block__prompt_kernel:
    s_load_dwordx16 s[64:79], s[0:1], 0
    s_load_dwordx2 s[4:5], s[0:1], 80
    s_load_dwordx2 s[6:7], s[0:1], 64
    s_load_dwordx2 s[60:61], s[0:1], 8
    s_cmp_ge_u32 s2, 256
    s_cbranch_scc1 L_end_main
    s_getpc_b64 s[32:33]
L_pc0:
    v_lshlrev_b32 v24, 6, v0
    v_min_u32 v24, L_text_end-L_pc0-4, v24
    global_load_dword v124, v24, s[32:33]
    v_lshrrev_b32 v4, 6, v0
    v_and_b32 v1, 63, v0
    v_readfirstlane_b32 s3, v4
    v_and_b32 v2, 31, v0
    v_bfe_u32 v3, v0, 5, 1
    v_lshlrev_b32 v1, 4, v1
    v_mov_b32 v122, 1
    v_mov_b32 v123, 163584
    v_mov_b32 v5, 0
    v_lshl_add_u32 v4, v2, 2, v123
    ds_write_b32 v4, v5
    s_and_b32 s16, s2, 7
    s_lshl_b32 s16, s16, 2
    s_lshr_b32 s22, s2, 6
    s_add_u32 s16, s16, s22
    s_bfe_u32 s17, s2, 0x30003
    s_lshl_b32 s18, s16, 1
    s_and_b32 s22, s17, 1
    s_add_u32 s18, s18, s22
    s_lshr_b32 s19, s17, 1
    s_and_b32 s46, s3, 3
    s_mov_b32 s20, 0
    s_mov_b32 s21, 0
    s_mov_b32 s59, 1
    s_lshl_b32 s47, s19, 2
    s_add_u32 s47, s47, s46
    s_lshl_b32 s22, s16, 12
    s_lshl_b32 s57, s17, 9
    s_add_u32 s57, s57, s22
    s_add_u32 s57, s57, 42991616
    s_mov_b32 s56, 0
    s_cmp_ge_u32 s3, 4
    s_cbranch_scc1 L_st_H_1
    v_lshrrev_b32 v16, 8, v1
    v_lshlrev_b32 v17, 4, v16
    v_and_b32 v18, 0xf0, v1
    v_xor_b32 v17, v17, v18
    v_lshl_add_u32 v128, v16, 10, v17
    v_xor_b32 v129, 64, v128
    v_xor_b32 v130, 0x80, v128
    v_xor_b32 v131, 0xc0, v128
    s_lshl_b32 s24, s18, 15
    s_lshl_b32 s23, s46, 8
    s_add_u32 s24, s24, s23
    s_lshl_b32 s25, s46, 13
    s_and_b32 s23, s24, 0x8000
    s_add_u32 s25, s25, s23
    s_add_u32 s25, s25, 65536
    s_lshl_b32 s29, s46, 12
    s_add_u32 s26, s29, 131072
    s_waitcnt lgkmcnt(0)
    s_mov_b32 s66, 0x200000
    s_mov_b32 s67, 0x20000
    s_add_u32 s34, s4, 42467328
    s_addc_u32 s35, s5, 0
    s_load_dword s58, s[34:35], 0
    s_lshl_b32 s23, s3, 2
    s_or_b32 s23, s23, s19
    s_cmp_lg_u32 s23, 2
    s_cbranch_scc1 L_st_t_2
    s_bitcmp1_b32 s18, 0
    s_cselect_b32 s80, s68, s70
    s_cselect_b32 s81, s69, s71
    s_bitcmp1_b32 s16, 0
    s_cselect_b32 s80, s80, s4
    s_cselect_b32 s81, s81, s5
    global_load_dword v125, v1, s[80:81]
L_st_t_2:
    s_mov_b32 s23, s25
    s_mov_b32 m0, s23
    s_add_u32 s23, s23, 1024
    buffer_load_dwordx4 v128, s[64:67], s24 offen lds
    s_add_u32 s24, s24, 4096
    s_mov_b32 m0, s23
    s_add_u32 s23, s23, 1024
    buffer_load_dwordx4 v129, s[64:67], s24 offen lds
    s_add_u32 s24, s24, 4096
    s_mov_b32 m0, s23
    s_add_u32 s23, s23, 1024
    buffer_load_dwordx4 v130, s[64:67], s24 offen lds
    s_add_u32 s24, s24, 4096
    s_mov_b32 m0, s23
    s_add_u32 s23, s23, 1024
    buffer_load_dwordx4 v131, s[64:67], s24 offen lds
    s_add_u32 s24, s24, 4096
    s_mov_b32 m0, s23
    s_add_u32 s23, s23, 1024
    buffer_load_dwordx4 v128, s[64:67], s24 offen lds
    s_add_u32 s24, s24, 4096
    s_mov_b32 m0, s23
    s_add_u32 s23, s23, 1024
    buffer_load_dwordx4 v129, s[64:67], s24 offen lds
    s_add_u32 s24, s24, 4096
    s_mov_b32 m0, s23
    s_add_u32 s23, s23, 1024
    buffer_load_dwordx4 v130, s[64:67], s24 offen lds
    s_add_u32 s24, s24, 4096
    s_mov_b32 m0, s23
    s_add_u32 s23, s23, 1024
    buffer_load_dwordx4 v131, s[64:67], s24 offen lds
    s_add_u32 s24, s24, 4096
    s_cmp_eq_u32 s19, 0
    s_cselect_b32 s80, s68, s70
    s_cselect_b32 s81, s69, s71
    s_mov_b32 s82, 0x4000
    s_mov_b32 s83, 0x20000
    s_mov_b32 m0, s26
    s_mov_b32 s41, 0
    s_mov_b32 s44, s26
    v_mov_b32 v160, 0
    s_cmp_ge_u32 s19, 2
    s_cbranch_scc1 L_st_prep_4
    buffer_load_dwordx4 v1, s[80:83], s29 offen offset:0 lds
    buffer_load_dwordx4 v1, s[80:83], s29 offen offset:1024 lds
    buffer_load_dwordx4 v1, s[80:83], s29 offen offset:2048 lds
    buffer_load_dwordx4 v1, s[80:83], s29 offen offset:3072 lds
L_st_none_3:
    s_mov_b32 s8, s4
    s_mov_b32 s9, s5
    s_mov_b32 s10, 0x3000000
    s_mov_b32 s11, 0x20000
    s_mov_b32 s12, s6
    s_mov_b32 s13, s7
    s_mov_b32 s14, 0x200000
    s_mov_b32 s15, 0x20000
    v_lshlrev_b32 v22, 8, v2
    v_lshl_add_u32 v22, v3, 3, v22
    v_and_b32 v21, 0xf0, v1
    v_or_b32 v22, v22, v21
    v_add_u32 v22, s25, v22
    v_add_u32 v112, s25, v1
    v_xor_b32 v132, 0, v22
    v_xor_b32 v133, 16, v22
    v_xor_b32 v134, 32, v22
    v_xor_b32 v135, 48, v22
    v_xor_b32 v136, 64, v22
    v_xor_b32 v137, 80, v22
    v_xor_b32 v138, 96, v22
    v_xor_b32 v139, 112, v22
    v_xor_b32 v140, 128, v22
    v_xor_b32 v141, 144, v22
    v_xor_b32 v142, 160, v22
    v_xor_b32 v143, 176, v22
    v_xor_b32 v144, 192, v22
    v_xor_b32 v145, 208, v22
    v_xor_b32 v146, 224, v22
    v_xor_b32 v147, 240, v22
    s_mov_b32 s39, 0x3f803f80
    v_bfe_u32 v113, v1, 6, 2
    v_lshl_add_u32 v113, v3, 2, v113
    v_lshlrev_b32 v113, 5, v113
    v_bfe_u32 v21, v1, 4, 2
    v_lshl_add_u32 v113, v21, 3, v113
    v_add_u32 v113, s26, v113
    v_add_u32 v119, s26, v1
    s_mul_i32 s23, s46, 768
    s_add_u32 s23, s23, 157184
    v_lshrrev_b32 v120, 2, v1
    v_add_u32 v121, 157184, v120
    v_add_u32 v120, s23, v120
    s_and_b32 s36, s17, 1
    s_lshl_b32 s23, s36, 2
    v_add_u32 v116, s23, v123
    s_lshl_b32 s23, s36, 8
    s_add_u32 s23, s23, 155648
    v_lshlrev_b32 v6, 2, v2
    v_add_u32 v6, s23, v6
    v_lshlrev_b32 v7, 4, v3
    v_add_u32 v7, s23, v7
    s_lshr_b32 s26, s18, 3
    s_lshl_b32 s27, s26, 14
    s_and_b32 s23, s18, 3
    s_lshl_b32 s23, s23, 12
    s_add_u32 s27, s27, s23
    s_and_b32 s23, s18, 4
    s_lshl_b32 s23, s23, 9
    s_add_u32 s27, s27, s23
    s_add_u32 s27, s27, s21
    s_add_u32 s27, s27, 16777216
    v_mov_b32 v32, 0
    v_mov_b32 v33, 0
    v_mov_b32 v34, 0
    v_mov_b32 v35, 0
    v_mov_b32 v36, 0
    v_mov_b32 v37, 0
    v_mov_b32 v38, 0
    v_mov_b32 v39, 0
    v_mov_b32 v40, 0
    v_mov_b32 v41, 0
    v_mov_b32 v42, 0
    v_mov_b32 v43, 0
    s_waitcnt lgkmcnt(0)
    s_add_u32 s62, s58, 64
    s_xor_b32 s63, s62, 0x5a3c96e1
    s_setprio 3
    s_barrier
    s_waitcnt vmcnt(1)
    s_cmp_ge_u32 s19, 2
    s_cbranch_scc1 L_st_w5_5
    s_waitcnt vmcnt(0)
L_st_w5_5:
    ds_read_b64 v[48:49], v132
    ds_read_b64 v[50:51], v133
    ds_read_b64 v[52:53], v134
    ds_read_b64 v[54:55], v135
    ds_read_b64 v[56:57], v136
    ds_read_b64 v[58:59], v137
    ds_read_b64 v[60:61], v138
    ds_read_b64 v[62:63], v139
    ds_read_b64 v[64:65], v140
    ds_read_b64 v[66:67], v141
    ds_read_b64 v[68:69], v142
    ds_read_b64 v[70:71], v143
    ds_read_b64 v[72:73], v144
    ds_read_b64 v[74:75], v145
    ds_read_b64 v[76:77], v146
    ds_read_b64 v[78:79], v147
    s_waitcnt lgkmcnt(0)
    ds_read_b64_tr_b16 v[80:81], v113 offset:0
    ds_read_b64_tr_b16 v[82:83], v113 offset:256
    ds_read_b64_tr_b16 v[84:85], v113 offset:512
    ds_read_b64_tr_b16 v[86:87], v113 offset:768
    ds_read_b64_tr_b16 v[88:89], v113 offset:1024
    ds_read_b64_tr_b16 v[90:91], v113 offset:1280
    ds_read_b64_tr_b16 v[92:93], v113 offset:1536
    ds_read_b64_tr_b16 v[94:95], v113 offset:1792
    ds_read_b64_tr_b16 v[96:97], v113 offset:2048
    ds_read_b64_tr_b16 v[98:99], v113 offset:2304
    ds_read_b64_tr_b16 v[100:101], v113 offset:2560
    ds_read_b64_tr_b16 v[102:103], v113 offset:2816
    ds_read_b64_tr_b16 v[104:105], v113 offset:3072
    ds_read_b64_tr_b16 v[106:107], v113 offset:3328
    ds_read_b64_tr_b16 v[108:109], v113 offset:3584
    ds_read_b64_tr_b16 v[110:111], v113 offset:3840
    v_dot2_f32_bf16 v32, v48, s39, v32
    v_dot2_f32_bf16 v36, v48, v48, v36
    v_dot2_f32_bf16 v33, v49, s39, v33
    v_dot2_f32_bf16 v37, v49, v49, v37
    v_dot2_f32_bf16 v34, v50, s39, v34
    v_dot2_f32_bf16 v38, v50, v50, v38
    v_dot2_f32_bf16 v35, v51, s39, v35
    v_dot2_f32_bf16 v39, v51, v51, v39
    v_dot2_f32_bf16 v32, v52, s39, v32
    v_dot2_f32_bf16 v36, v52, v52, v36
    v_dot2_f32_bf16 v33, v53, s39, v33
    v_dot2_f32_bf16 v37, v53, v53, v37
    v_dot2_f32_bf16 v34, v54, s39, v34
    v_dot2_f32_bf16 v38, v54, v54, v38
    v_dot2_f32_bf16 v35, v55, s39, v35
    v_dot2_f32_bf16 v39, v55, v55, v39
    v_dot2_f32_bf16 v32, v56, s39, v32
    v_dot2_f32_bf16 v36, v56, v56, v36
    v_dot2_f32_bf16 v33, v57, s39, v33
    v_dot2_f32_bf16 v37, v57, v57, v37
    v_dot2_f32_bf16 v34, v58, s39, v34
    v_dot2_f32_bf16 v38, v58, v58, v38
    v_dot2_f32_bf16 v35, v59, s39, v35
    v_dot2_f32_bf16 v39, v59, v59, v39
    v_dot2_f32_bf16 v32, v60, s39, v32
    v_dot2_f32_bf16 v36, v60, v60, v36
    v_dot2_f32_bf16 v33, v61, s39, v33
    v_dot2_f32_bf16 v37, v61, v61, v37
    v_dot2_f32_bf16 v34, v62, s39, v34
    v_dot2_f32_bf16 v38, v62, v62, v38
    v_dot2_f32_bf16 v35, v63, s39, v35
    v_dot2_f32_bf16 v39, v63, v63, v39
    v_dot2_f32_bf16 v32, v64, s39, v32
    v_dot2_f32_bf16 v36, v64, v64, v36
    v_dot2_f32_bf16 v33, v65, s39, v33
    v_dot2_f32_bf16 v37, v65, v65, v37
    v_dot2_f32_bf16 v34, v66, s39, v34
    v_dot2_f32_bf16 v38, v66, v66, v38
    v_dot2_f32_bf16 v35, v67, s39, v35
    v_dot2_f32_bf16 v39, v67, v67, v39
    v_dot2_f32_bf16 v32, v68, s39, v32
    v_dot2_f32_bf16 v36, v68, v68, v36
    v_dot2_f32_bf16 v33, v69, s39, v33
    v_dot2_f32_bf16 v37, v69, v69, v37
    v_dot2_f32_bf16 v34, v70, s39, v34
    v_dot2_f32_bf16 v38, v70, v70, v38
    v_dot2_f32_bf16 v35, v71, s39, v35
    v_dot2_f32_bf16 v39, v71, v71, v39
    v_dot2_f32_bf16 v32, v72, s39, v32
    v_dot2_f32_bf16 v36, v72, v72, v36
    v_dot2_f32_bf16 v33, v73, s39, v33
    v_dot2_f32_bf16 v37, v73, v73, v37
    v_dot2_f32_bf16 v34, v74, s39, v34
    v_dot2_f32_bf16 v38, v74, v74, v38
    v_dot2_f32_bf16 v35, v75, s39, v35
    v_dot2_f32_bf16 v39, v75, v75, v39
    v_dot2_f32_bf16 v32, v76, s39, v32
    v_dot2_f32_bf16 v36, v76, v76, v36
    v_dot2_f32_bf16 v33, v77, s39, v33
    v_dot2_f32_bf16 v37, v77, v77, v37
    v_dot2_f32_bf16 v34, v78, s39, v34
    v_dot2_f32_bf16 v38, v78, v78, v38
    v_dot2_f32_bf16 v35, v79, s39, v35
    v_dot2_f32_bf16 v39, v79, v79, v39
    s_waitcnt lgkmcnt(0)
    s_cmp_ge_u32 s19, 2
    s_cbranch_scc1 L_st_j_7
    v_dot2_f32_bf16 v40, v80, s39, v40
    v_dot2_f32_bf16 v41, v81, s39, v41
    v_dot2_f32_bf16 v42, v82, s39, v42
    v_dot2_f32_bf16 v43, v83, s39, v43
    v_dot2_f32_bf16 v40, v84, s39, v40
    v_dot2_f32_bf16 v41, v85, s39, v41
    v_dot2_f32_bf16 v42, v86, s39, v42
    v_dot2_f32_bf16 v43, v87, s39, v43
    v_dot2_f32_bf16 v40, v88, s39, v40
    v_dot2_f32_bf16 v41, v89, s39, v41
    v_dot2_f32_bf16 v42, v90, s39, v42
    v_dot2_f32_bf16 v43, v91, s39, v43
    v_dot2_f32_bf16 v40, v92, s39, v40
    v_dot2_f32_bf16 v41, v93, s39, v41
    v_dot2_f32_bf16 v42, v94, s39, v42
    v_dot2_f32_bf16 v43, v95, s39, v43
    v_dot2_f32_bf16 v40, v96, s39, v40
    v_dot2_f32_bf16 v41, v97, s39, v41
    v_dot2_f32_bf16 v42, v98, s39, v42
    v_dot2_f32_bf16 v43, v99, s39, v43
    v_dot2_f32_bf16 v40, v100, s39, v40
    v_dot2_f32_bf16 v41, v101, s39, v41
    v_dot2_f32_bf16 v42, v102, s39, v42
    v_dot2_f32_bf16 v43, v103, s39, v43
    v_dot2_f32_bf16 v40, v104, s39, v40
    v_dot2_f32_bf16 v41, v105, s39, v41
    v_dot2_f32_bf16 v42, v106, s39, v42
    v_dot2_f32_bf16 v43, v107, s39, v43
    v_dot2_f32_bf16 v40, v108, s39, v40
    v_dot2_f32_bf16 v41, v109, s39, v41
    v_dot2_f32_bf16 v42, v110, s39, v42
    v_dot2_f32_bf16 v43, v111, s39, v43
    s_cmp_eq_u32 s19, 1
    s_cbranch_scc1 L_st_v_6
    v_mfma_f32_32x32x16_bf16 v[16:31], v[80:83], v[48:51], 0
    v_mfma_f32_32x32x16_bf16 v[16:31], v[84:87], v[52:55], v[16:31]
    v_mfma_f32_32x32x16_bf16 v[16:31], v[88:91], v[56:59], v[16:31]
    v_mfma_f32_32x32x16_bf16 v[16:31], v[92:95], v[60:63], v[16:31]
    v_mfma_f32_32x32x16_bf16 v[16:31], v[96:99], v[64:67], v[16:31]
    v_mfma_f32_32x32x16_bf16 v[16:31], v[100:103], v[68:71], v[16:31]
    v_mfma_f32_32x32x16_bf16 v[16:31], v[104:107], v[72:75], v[16:31]
    v_mfma_f32_32x32x16_bf16 v[16:31], v[108:111], v[76:79], v[16:31]
    s_branch L_st_j_7
L_st_v_6:
    v_mfma_f32_32x32x16_bf16 v[16:31], v[48:51], v[80:83], 0
    v_mfma_f32_32x32x16_bf16 v[16:31], v[52:55], v[84:87], v[16:31]
    v_mfma_f32_32x32x16_bf16 v[16:31], v[56:59], v[88:91], v[16:31]
    v_mfma_f32_32x32x16_bf16 v[16:31], v[60:63], v[92:95], v[16:31]
    v_mfma_f32_32x32x16_bf16 v[16:31], v[64:67], v[96:99], v[16:31]
    v_mfma_f32_32x32x16_bf16 v[16:31], v[68:71], v[100:103], v[16:31]
    v_mfma_f32_32x32x16_bf16 v[16:31], v[72:75], v[104:107], v[16:31]
    v_mfma_f32_32x32x16_bf16 v[16:31], v[76:79], v[108:111], v[16:31]
L_st_j_7:
    v_add_f32 v32, v32, v33
    v_add_f32 v34, v34, v35
    v_add_f32 v36, v36, v37
    v_add_f32 v38, v38, v39
    v_add_f32 v32, v32, v34
    v_add_f32 v36, v36, v38
    s_nop 1
    v_permlane32_swap_b32 v32, v36
    v_add_f32 v32, v32, v36
    v_add_f32 v40, v40, v41
    v_add_f32 v42, v42, v43
    v_add_f32 v33, v40, v42
    s_cmp_eq_u32 s3, 0
    s_cbranch_scc1 L_st_w0_8
    ds_write_b32 v120, v32
    ds_write_b32 v120, v33 offset:256
    s_cmp_ge_u32 s19, 2
    s_cbranch_scc1 L_st_sk_10
    ds_write_b128 v119, v[16:19] offset:0
    ds_write_b128 v119, v[20:23] offset:1024
    ds_write_b128 v119, v[24:27] offset:2048
    ds_write_b128 v119, v[28:31] offset:3072
L_st_sk_10:
    s_mov_b64 exec, 1
    ds_add_u32 v123, v122 offset:24
    s_mov_b64 exec, -1
    ds_write_b128 v112, v[48:51] offset:0
    ds_write_b128 v112, v[52:55] offset:1024
    ds_write_b128 v112, v[56:59] offset:2048
    ds_write_b128 v112, v[60:63] offset:3072
    ds_write_b128 v112, v[64:67] offset:4096
    ds_write_b128 v112, v[68:71] offset:5120
    ds_write_b128 v112, v[72:75] offset:6144
    ds_write_b128 v112, v[76:79] offset:7168
    s_mov_b64 exec, 1
    ds_add_u32 v116, v122 offset:48
    s_mov_b64 exec, -1
    s_branch L_st_2nd_9
L_st_w0_8:
    ds_write_b128 v112, v[48:51] offset:0
    ds_write_b128 v112, v[52:55] offset:1024
    ds_write_b128 v112, v[56:59] offset:2048
    ds_write_b128 v112, v[60:63] offset:3072
    ds_write_b128 v112, v[64:67] offset:4096
    ds_write_b128 v112, v[68:71] offset:5120
    ds_write_b128 v112, v[72:75] offset:6144
    ds_write_b128 v112, v[76:79] offset:7168
L_cw_11:
    ds_read_b32 v4, v123 offset:24
    s_waitcnt lgkmcnt(0)
    v_readfirstlane_b32 s22, v4
    s_nop 0
    s_cmp_lt_u32 s22, 3
    s_cbranch_scc1 L_cw_11
    ds_read2st64_b32 v[34:35], v120 offset0:3 offset1:4
    ds_read2st64_b32 v[36:37], v120 offset0:6 offset1:7
    ds_read2st64_b32 v[38:39], v120 offset0:9 offset1:10
    ds_read_b128 v[48:51], v119 offset:4096
    ds_read_b128 v[52:55], v119 offset:5120
    ds_read_b128 v[56:59], v119 offset:6144
    ds_read_b128 v[60:63], v119 offset:7168
    ds_read_b128 v[64:67], v119 offset:8192
    ds_read_b128 v[68:71], v119 offset:9216
    ds_read_b128 v[72:75], v119 offset:10240
    ds_read_b128 v[76:79], v119 offset:11264
    ds_read_b128 v[80:83], v119 offset:12288
    ds_read_b128 v[84:87], v119 offset:13312
    ds_read_b128 v[88:91], v119 offset:14336
    ds_read_b128 v[92:95], v119 offset:15360
    s_waitcnt lgkmcnt(12)
    v_add_f32 v32, v32, v34
    v_add_f32 v33, v33, v35
    v_add_f32 v32, v32, v36
    v_add_f32 v33, v33, v37
    v_add_f32 v32, v32, v38
    v_add_f32 v33, v33, v39
    v_mov_b32 v34, v33
    v_mul_f32 v114, 0x3b000000, v32
    s_nop 0
    v_mov_b32 v115, v114
    s_nop 1
    v_permlane32_swap_b32 v114, v115
    v_fma_f32 v115, -v114, v114, v115
    v_max_f32 v115, 0, v115
    v_add_f32 v115, 0x3727c5ac, v115
    v_rsq_f32 v115, v115
    v_permlane32_swap_b32 v33, v34
    v_lshlrev_b32 v4, 2, v2
    v_add_f32 v33, v33, v34
    ds_write_b32 v6, v114
    ds_write_b32 v6, v115 offset:128
    v_add_u32 v4, 156672, v4
    v_lshlrev_b32 v5, 4, v3
    v_add_u32 v35, 156672, v5
    ds_write_b32 v4, v33
    s_mov_b64 exec, 1
    ds_add_u32 v116, v122 offset:48
    s_mov_b64 exec, -1
    s_cmp_ge_u32 s19, 2
    s_cbranch_scc1 L_st_nj_14
    s_cmp_eq_u32 s19, 1
    s_cbranch_scc1 L_st_v2_12
    ds_read_b128 v[96:99], v35 offset:0
    ds_read_b128 v[100:103], v35 offset:32
    v_and_b32 v118, 0x330, v1
    v_bfe_u32 v5, v1, 6, 1
    v_lshl_or_b32 v118, v5, 7, v118
    v_bfe_u32 v5, v1, 7, 1
    v_lshl_or_b32 v118, v5, 6, v118
    s_waitcnt lgkmcnt(5)
    v_add_f32 v16, v16, v48
    v_add_f32 v17, v17, v49
    v_add_f32 v18, v18, v50
    v_add_f32 v19, v19, v51
    v_add_f32 v20, v20, v52
    v_add_f32 v21, v21, v53
    v_add_f32 v22, v22, v54
    v_add_f32 v23, v23, v55
    v_add_f32 v16, v16, v64
    v_add_f32 v17, v17, v65
    v_add_f32 v18, v18, v66
    v_add_f32 v19, v19, v67
    v_add_f32 v20, v20, v68
    v_add_f32 v21, v21, v69
    v_add_f32 v22, v22, v70
    v_add_f32 v23, v23, v71
    v_add_f32 v16, v16, v80
    v_add_f32 v17, v17, v81
    v_add_f32 v18, v18, v82
    v_add_f32 v19, v19, v83
    v_add_f32 v20, v20, v84
    v_add_f32 v21, v21, v85
    v_add_f32 v22, v22, v86
    v_add_f32 v23, v23, v87
    s_waitcnt lgkmcnt(0)
    v_fma_f32 v16, -v114, v96, v16
    v_fma_f32 v17, -v114, v97, v17
    v_fma_f32 v18, -v114, v98, v18
    v_fma_f32 v19, -v114, v99, v19
    v_fma_f32 v20, -v114, v100, v20
    v_fma_f32 v21, -v114, v101, v21
    v_fma_f32 v22, -v114, v102, v22
    v_fma_f32 v23, -v114, v103, v23
    v_mul_f32 v16, v115, v16
    v_mul_f32 v17, v115, v17
    v_mul_f32 v18, v115, v18
    v_mul_f32 v19, v115, v19
    v_mul_f32 v20, v115, v20
    v_mul_f32 v21, v115, v21
    v_mul_f32 v22, v115, v22
    v_mul_f32 v23, v115, v23
    v_cvt_pk_bf16_f32 v16, v16, v17
    v_cvt_pk_bf16_f32 v17, v18, v19
    v_cvt_pk_bf16_f32 v18, v20, v21
    v_cvt_pk_bf16_f32 v19, v22, v23
    buffer_store_dwordx4 v[16:19], v118, s[8:11], s27 offen sc0 sc1
    s_branch L_st_arr_13
L_st_v2_12:
    v_mov_b32 v114, v33
    s_waitcnt lgkmcnt(0)
    ds_read_b128 v[32:35], v7 offset:0
    ds_read_b128 v[96:99], v7 offset:128
    ds_read_b128 v[36:39], v7 offset:32
    ds_read_b128 v[100:103], v7 offset:160
    ds_read_b128 v[40:43], v7 offset:64
    ds_read_b128 v[104:107], v7 offset:192
    ds_read_b128 v[44:47], v7 offset:96
    ds_read_b128 v[108:111], v7 offset:224
    v_and_b32 v118, 15, v2
    v_lshl_add_u32 v118, v3, 4, v118
    v_lshlrev_b32 v118, 4, v118
    v_pk_add_f32 v[16:17], v[16:17], v[48:49]
    v_pk_add_f32 v[18:19], v[18:19], v[50:51]
    v_pk_add_f32 v[20:21], v[20:21], v[52:53]
    v_pk_add_f32 v[22:23], v[22:23], v[54:55]
    v_pk_add_f32 v[24:25], v[24:25], v[56:57]
    v_pk_add_f32 v[26:27], v[26:27], v[58:59]
    v_pk_add_f32 v[28:29], v[28:29], v[60:61]
    v_pk_add_f32 v[30:31], v[30:31], v[62:63]
    v_pk_add_f32 v[16:17], v[16:17], v[64:65]
    v_pk_add_f32 v[18:19], v[18:19], v[66:67]
    v_pk_add_f32 v[20:21], v[20:21], v[68:69]
    v_pk_add_f32 v[22:23], v[22:23], v[70:71]
    v_pk_add_f32 v[24:25], v[24:25], v[72:73]
    v_pk_add_f32 v[26:27], v[26:27], v[74:75]
    v_pk_add_f32 v[28:29], v[28:29], v[76:77]
    v_pk_add_f32 v[30:31], v[30:31], v[78:79]
    v_pk_add_f32 v[16:17], v[16:17], v[80:81]
    v_pk_add_f32 v[18:19], v[18:19], v[82:83]
    v_pk_add_f32 v[20:21], v[20:21], v[84:85]
    v_pk_add_f32 v[22:23], v[22:23], v[86:87]
    v_pk_add_f32 v[24:25], v[24:25], v[88:89]
    v_pk_add_f32 v[26:27], v[26:27], v[90:91]
    v_pk_add_f32 v[28:29], v[28:29], v[92:93]
    v_pk_add_f32 v[30:31], v[30:31], v[94:95]
    s_waitcnt lgkmcnt(0)
    v_fma_f32 v16, -v32, v114, v16
    v_fma_f32 v17, -v33, v114, v17
    v_fma_f32 v18, -v34, v114, v18
    v_fma_f32 v19, -v35, v114, v19
    v_fma_f32 v20, -v36, v114, v20
    v_fma_f32 v21, -v37, v114, v21
    v_fma_f32 v22, -v38, v114, v22
    v_fma_f32 v23, -v39, v114, v23
    v_fma_f32 v24, -v40, v114, v24
    v_fma_f32 v25, -v41, v114, v25
    v_fma_f32 v26, -v42, v114, v26
    v_fma_f32 v27, -v43, v114, v27
    v_fma_f32 v28, -v44, v114, v28
    v_fma_f32 v29, -v45, v114, v29
    v_fma_f32 v30, -v46, v114, v30
    v_fma_f32 v31, -v47, v114, v31
    v_mul_f32 v16, v96, v16
    v_mul_f32 v17, v97, v17
    v_mul_f32 v18, v98, v18
    v_mul_f32 v19, v99, v19
    v_mul_f32 v20, v100, v20
    v_mul_f32 v21, v101, v21
    v_mul_f32 v22, v102, v22
    v_mul_f32 v23, v103, v23
    v_mul_f32 v24, v104, v24
    v_mul_f32 v25, v105, v25
    v_mul_f32 v26, v106, v26
    v_mul_f32 v27, v107, v27
    v_mul_f32 v28, v108, v28
    v_mul_f32 v29, v109, v29
    v_mul_f32 v30, v110, v30
    v_mul_f32 v31, v111, v31
    v_cvt_pk_bf16_f32 v16, v16, v17
    v_cvt_pk_bf16_f32 v17, v18, v19
    v_cvt_pk_bf16_f32 v18, v20, v21
    v_cvt_pk_bf16_f32 v19, v22, v23
    v_cvt_pk_bf16_f32 v20, v24, v25
    v_cvt_pk_bf16_f32 v21, v26, v27
    v_cvt_pk_bf16_f32 v22, v28, v29
    v_cvt_pk_bf16_f32 v23, v30, v31
    s_mov_b32 exec_lo, 0xffff0000
    s_mov_b32 exec_hi, 0xffff0000
    buffer_store_dwordx4 v[16:19], v118, s[8:11], s27 offen offset:1024 sc0 sc1
    buffer_store_dwordx4 v[20:23], v118, s[8:11], s27 offen offset:1536 sc0 sc1
    s_mov_b64 exec, -1
L_st_arr_13:
    s_lshr_b32 s37, s18, 3
    s_mul_i32 s37, s37, 4352
    s_and_b32 s23, s18, 7
    s_lshl_b32 s23, s23, 2
    s_add_u32 s23, s23, s19
    s_lshl_b32 s23, s23, 3
    s_add_u32 s37, s37, s23
    s_add_u32 s37, s37, 42082304
    v_mov_b32 v4, s62
    v_mov_b32 v5, s63
    v_mov_b32 v6, 0
    s_mov_b64 exec, 1
    s_waitcnt vmcnt(0)
    buffer_store_dwordx2 v[4:5], v6, s[8:11], s37 offen sc0 sc1
    s_mov_b64 exec, -1
    s_branch L_st_2nd_9
L_st_nj_14:
L_st_2nd_9:
    s_setprio 0
    v_mov_b32 v22, 0
    v_lshlrev_b32 v21, 2, v2
    s_lshl_b32 s23, s46, 7
    s_add_u32 s23, s23, s57
    buffer_store_dword v22, v21, s[8:11], s23 offen sc0 sc1
    s_cmp_lg_u32 s3, 3
    s_cbranch_scc1 L_st_xc_15
    s_getreg_b32 s23, hwreg(HW_REG_XCC_ID, 0, 4)
    v_mov_b32 v21, s23
    s_mul_i32 s23, s16, 4352
    s_lshl_b32 s22, s17, 2
    s_add_u32 s23, s23, s22
    s_add_u32 s23, s23, 41943168
    s_mov_b64 exec, 1
    buffer_store_dword v21, v22, s[8:11], s23 offen sc0 sc1
    s_mov_b64 exec, -1
L_st_xc_15:
L_cw_16:
    ds_read_b32 v4, v116 offset:48
    s_waitcnt lgkmcnt(0)
    v_readfirstlane_b32 s22, v4
    s_nop 0
    s_cmp_lt_u32 s22, 4
    s_cbranch_scc1 L_cw_16
    s_lshl_b32 s23, s47, 11
    s_lshl_b32 s22, s36, 15
    s_add_u32 s23, s23, s22
    s_add_u32 s23, s23, 65536
    v_add_u32 v4, s23, v1
    ds_read_b128 v[8:11], v4
    ds_read_b128 v[12:15], v4 offset:1024
    s_cmp_lg_u32 s41, 1
    s_cbranch_scc1 L_qa_end
    s_mov_b32 s36, s43
L_cw_17:
    ds_read_b32 v4, v123 offset:60
    s_waitcnt lgkmcnt(0)
    v_readfirstlane_b32 s22, v4
    s_nop 0
    s_cmp_lt_u32 s22, 4
    s_cbranch_scc1 L_cw_17
    s_cmp_lg_u32 s43, 16
    s_cbranch_scc1 L_st_sd_18
    s_mov_b32 s72, s68
    s_mov_b32 s73, s69
    s_mov_b32 s74, 0x4000
    s_mov_b32 s75, 0x20000
    s_mov_b32 s23, s44
    s_mov_b32 s22, s42
    s_mov_b32 exec_lo, 0x33333333
    s_mov_b32 exec_hi, 0x33333333
    s_mov_b32 m0, s23
    s_add_u32 s23, s23, 1024
    buffer_load_dwordx4 v160, s[72:75], s22 offen lds
    s_add_u32 s22, s22, s38
    s_mov_b32 m0, s23
    s_add_u32 s23, s23, 1024
    buffer_load_dwordx4 v160, s[72:75], s22 offen lds
    s_add_u32 s22, s22, s38
    s_mov_b32 m0, s23
    s_add_u32 s23, s23, 1024
    buffer_load_dwordx4 v160, s[72:75], s22 offen lds
    s_add_u32 s22, s22, s38
    s_mov_b32 m0, s23
    s_add_u32 s23, s23, 1024
    buffer_load_dwordx4 v160, s[72:75], s22 offen lds
    s_add_u32 s22, s22, s38
    s_waitcnt vmcnt(0)
    s_mov_b32 exec_lo, 0xcccccccc
    s_mov_b32 exec_hi, 0xcccccccc
L_st_sd_18:
    s_mov_b32 s23, s44
    s_mov_b32 m0, s23
    s_add_u32 s23, s23, 1024
    buffer_load_dwordx4 v160, s[80:83], s42 offen lds
    s_add_u32 s42, s42, s38
    s_mov_b32 m0, s23
    s_add_u32 s23, s23, 1024
    buffer_load_dwordx4 v160, s[80:83], s42 offen lds
    s_add_u32 s42, s42, s38
    s_mov_b32 m0, s23
    s_add_u32 s23, s23, 1024
    buffer_load_dwordx4 v160, s[80:83], s42 offen lds
    s_add_u32 s42, s42, s38
    s_mov_b32 m0, s23
    s_add_u32 s23, s23, 1024
    buffer_load_dwordx4 v160, s[80:83], s42 offen lds
    s_add_u32 s42, s42, s38
    s_mov_b64 exec, -1
    v_bfe_u32 v113, v1, 6, 2
    v_lshl_add_u32 v113, v3, 2, v113
    v_lshlrev_b32 v113, 6, v113
    v_bfe_u32 v4, v1, 8, 1
    v_lshl_add_u32 v113, v4, 5, v113
    v_bfe_u32 v4, v1, 4, 2
    v_lshl_add_u32 v113, v4, 3, v113
    v_add_u32 v113, s44, v113
    v_mov_b32 v32, 0
    v_mov_b32 v33, 0
    v_mov_b32 v34, 0
    v_mov_b32 v35, 0
    s_lshl_b32 s24, s36, 15
    s_lshl_b32 s25, s46, 13
    s_add_u32 s24, s24, s25
    s_add_u32 s25, s24, 4096
    s_waitcnt vmcnt(0)
    ds_read_b64_tr_b16 v[80:81], v113 offset:0
    ds_read_b64_tr_b16 v[82:83], v113 offset:512
    ds_read_b64_tr_b16 v[84:85], v113 offset:1024
    ds_read_b64_tr_b16 v[86:87], v113 offset:1536
    ds_read_b64_tr_b16 v[88:89], v113 offset:2048
    ds_read_b64_tr_b16 v[90:91], v113 offset:2560
    ds_read_b64_tr_b16 v[92:93], v113 offset:3072
    ds_read_b64_tr_b16 v[94:95], v113 offset:3584
    s_waitcnt lgkmcnt(0)
    s_cmp_lg_u32 s43, 16
    s_cbranch_scc1 L_st_sd_19
    s_mov_b32 s72, s68
    s_mov_b32 s73, s69
    s_mov_b32 s74, 0x4000
    s_mov_b32 s75, 0x20000
    s_mov_b32 s23, s44
    s_mov_b32 s22, s42
    s_mov_b32 exec_lo, 0x33333333
    s_mov_b32 exec_hi, 0x33333333
    s_mov_b32 m0, s23
    s_add_u32 s23, s23, 1024
    buffer_load_dwordx4 v160, s[72:75], s22 offen lds
    s_add_u32 s22, s22, s38
    s_mov_b32 m0, s23
    s_add_u32 s23, s23, 1024
    buffer_load_dwordx4 v160, s[72:75], s22 offen lds
    s_add_u32 s22, s22, s38
    s_mov_b32 m0, s23
    s_add_u32 s23, s23, 1024
    buffer_load_dwordx4 v160, s[72:75], s22 offen lds
    s_add_u32 s22, s22, s38
    s_mov_b32 m0, s23
    s_add_u32 s23, s23, 1024
    buffer_load_dwordx4 v160, s[72:75], s22 offen lds
    s_add_u32 s22, s22, s38
    s_waitcnt vmcnt(0)
    s_mov_b32 exec_lo, 0xcccccccc
    s_mov_b32 exec_hi, 0xcccccccc
L_st_sd_19:
    s_mov_b32 s23, s44
    s_mov_b32 m0, s23
    s_add_u32 s23, s23, 1024
    buffer_load_dwordx4 v160, s[80:83], s42 offen lds
    s_add_u32 s42, s42, s38
    s_mov_b32 m0, s23
    s_add_u32 s23, s23, 1024
    buffer_load_dwordx4 v160, s[80:83], s42 offen lds
    s_add_u32 s42, s42, s38
    s_mov_b32 m0, s23
    s_add_u32 s23, s23, 1024
    buffer_load_dwordx4 v160, s[80:83], s42 offen lds
    s_add_u32 s42, s42, s38
    s_mov_b32 m0, s23
    s_add_u32 s23, s23, 1024
    buffer_load_dwordx4 v160, s[80:83], s42 offen lds
    s_add_u32 s42, s42, s38
    s_mov_b64 exec, -1
    buffer_store_dwordx4 v[80:83], v1, s[8:11], s24 offen offset:0 sc0 sc1
    buffer_store_dwordx4 v[84:87], v1, s[8:11], s24 offen offset:1024 sc0 sc1
    buffer_store_dwordx4 v[88:91], v1, s[8:11], s24 offen offset:2048 sc0 sc1
    buffer_store_dwordx4 v[92:95], v1, s[8:11], s24 offen offset:3072 sc0 sc1
    s_waitcnt vmcnt(4)
    ds_read_b64_tr_b16 v[96:97], v113 offset:0
    ds_read_b64_tr_b16 v[98:99], v113 offset:512
    ds_read_b64_tr_b16 v[100:101], v113 offset:1024
    ds_read_b64_tr_b16 v[102:103], v113 offset:1536
    ds_read_b64_tr_b16 v[104:105], v113 offset:2048
    ds_read_b64_tr_b16 v[106:107], v113 offset:2560
    ds_read_b64_tr_b16 v[108:109], v113 offset:3072
    ds_read_b64_tr_b16 v[110:111], v113 offset:3584
    s_waitcnt lgkmcnt(0)
    buffer_store_dwordx4 v[96:99], v1, s[8:11], s25 offen offset:0 sc0 sc1
    buffer_store_dwordx4 v[100:103], v1, s[8:11], s25 offen offset:1024 sc0 sc1
    buffer_store_dwordx4 v[104:107], v1, s[8:11], s25 offen offset:2048 sc0 sc1
    buffer_store_dwordx4 v[108:111], v1, s[8:11], s25 offen offset:3072 sc0 sc1
    v_dot2_f32_bf16 v32, v80, s39, v32
    v_dot2_f32_bf16 v33, v81, s39, v33
    v_dot2_f32_bf16 v34, v82, s39, v34
    v_dot2_f32_bf16 v35, v83, s39, v35
    v_dot2_f32_bf16 v32, v84, s39, v32
    v_dot2_f32_bf16 v33, v85, s39, v33
    v_dot2_f32_bf16 v34, v86, s39, v34
    v_dot2_f32_bf16 v35, v87, s39, v35
    v_dot2_f32_bf16 v32, v88, s39, v32
    v_dot2_f32_bf16 v33, v89, s39, v33
    v_dot2_f32_bf16 v34, v90, s39, v34
    v_dot2_f32_bf16 v35, v91, s39, v35
    v_dot2_f32_bf16 v32, v92, s39, v32
    v_dot2_f32_bf16 v33, v93, s39, v33
    v_dot2_f32_bf16 v34, v94, s39, v34
    v_dot2_f32_bf16 v35, v95, s39, v35
    v_dot2_f32_bf16 v32, v96, s39, v32
    v_dot2_f32_bf16 v33, v97, s39, v33
    v_dot2_f32_bf16 v34, v98, s39, v34
    v_dot2_f32_bf16 v35, v99, s39, v35
    v_dot2_f32_bf16 v32, v100, s39, v32
    v_dot2_f32_bf16 v33, v101, s39, v33
    v_dot2_f32_bf16 v34, v102, s39, v34
    v_dot2_f32_bf16 v35, v103, s39, v35
    v_dot2_f32_bf16 v32, v104, s39, v32
    v_dot2_f32_bf16 v33, v105, s39, v33
    v_dot2_f32_bf16 v34, v106, s39, v34
    v_dot2_f32_bf16 v35, v107, s39, v35
    v_dot2_f32_bf16 v32, v108, s39, v32
    v_dot2_f32_bf16 v33, v109, s39, v33
    v_dot2_f32_bf16 v34, v110, s39, v34
    v_dot2_f32_bf16 v35, v111, s39, v35
    s_nop 2
    v_add_f32 v32, v32, v33
    v_add_f32 v34, v34, v35
    v_add_f32 v32, v32, v34
    ds_write_b32 v120, v32 offset:256
    s_waitcnt lgkmcnt(0)
    s_mov_b64 exec, 1
    ds_add_u32 v123, v122 offset:24
    s_mov_b64 exec, -1
    s_cmp_lg_u32 s3, 0
    s_cbranch_scc1 L_qa_end
L_cw_20:
    ds_read_b32 v4, v123 offset:24
    s_waitcnt lgkmcnt(0)
    v_readfirstlane_b32 s22, v4
    s_nop 0
    s_cmp_lt_u32 s22, 7
    s_cbranch_scc1 L_cw_20
    ds_read2st64_b32 v[32:33], v121 offset0:1 offset1:4
    ds_read2st64_b32 v[34:35], v121 offset0:7 offset1:10
    s_waitcnt lgkmcnt(0)
    v_add_f32 v32, v32, v33
    v_add_f32 v34, v34, v35
    v_add_f32 v32, v32, v34
    v_mov_b32 v33, v32
    s_lshl_b32 s23, s36, 7
    s_add_u32 s23, s23, 3211264
    v_lshlrev_b32 v4, 2, v2
    v_permlane32_swap_b32 v32, v33
    v_add_f32 v32, v32, v33
    buffer_store_dword v32, v4, s[8:11], s23 offen sc0 sc1
    s_branch L_qa_end
L_st_H_1:
    v_lshrrev_b32 v24, 7, v1
    v_lshlrev_b32 v24, 10, v24
    v_and_b32 v17, 0x70, v1
    v_lshrrev_b32 v18, 2, v1
    v_and_b32 v18, 64, v18
    v_xor_b32 v17, v17, v18
    v_add_u32 v24, v24, v17
    s_lshl_b32 s28, s17, 7
    s_lshl_b32 s23, s46, 17
    s_add_u32 s28, s28, s23
    s_lshl_b32 s26, s46, 14
    s_and_b32 s27, s16, 3
    s_waitcnt lgkmcnt(0)
    s_mov_b32 s80, s66
    s_mov_b32 s81, s67
    s_mov_b32 s82, 0x80000
    s_mov_b32 s83, 0x20000
    s_mov_b32 s66, 0x200000
    s_mov_b32 s67, 0x20000
    s_add_u32 s34, s4, 42467328
    s_addc_u32 s35, s5, 0
    s_load_dword s58, s[34:35], 0
    s_lshl_b32 s22, s27, 15
    s_add_u32 s22, s22, s28
    s_lshl_b32 s23, s27, 12
    s_add_u32 s23, s23, s26
    s_add_u32 s27, s27, 1
    s_and_b32 s27, s27, 3
    s_mov_b32 m0, s23
    s_add_u32 s23, s23, 1024
    buffer_load_dwordx4 v24, s[80:83], s22 offen lds
    s_add_u32 s22, s22, 8192
    s_mov_b32 m0, s23
    s_add_u32 s23, s23, 1024
    buffer_load_dwordx4 v24, s[80:83], s22 offen lds
    s_add_u32 s22, s22, 8192
    s_mov_b32 m0, s23
    s_add_u32 s23, s23, 1024
    buffer_load_dwordx4 v24, s[80:83], s22 offen lds
    s_add_u32 s22, s22, 8192
    s_mov_b32 m0, s23
    s_add_u32 s23, s23, 1024
    buffer_load_dwordx4 v24, s[80:83], s22 offen lds
    s_add_u32 s22, s22, 8192
    v_lshrrev_b32 v16, 8, v1
    v_lshlrev_b32 v17, 4, v16
    v_and_b32 v18, 0xf0, v1
    v_xor_b32 v17, v17, v18
    v_lshl_add_u32 v80, v16, 10, v17
    v_xor_b32 v81, 64, v80
    v_xor_b32 v82, 0x80, v80
    v_xor_b32 v83, 0xc0, v80
    s_lshl_b32 s24, s18, 15
    s_lshl_b32 s23, s46, 8
    s_add_u32 s24, s24, s23
    s_xor_b32 s24, s24, 0x8000
    s_lshl_b32 s25, s46, 13
    s_and_b32 s23, s24, 0x8000
    s_add_u32 s25, s25, s23
    s_add_u32 s25, s25, 65536
    s_mov_b32 s8, s4
    s_mov_b32 s9, s5
    s_mov_b32 s10, 0x3000000
    s_mov_b32 s11, 0x20000
    s_mov_b32 s12, s6
    s_mov_b32 s13, s7
    s_mov_b32 s14, 0x200000
    s_mov_b32 s15, 0x20000
    v_lshlrev_b32 v22, 8, v2
    v_lshl_add_u32 v22, v3, 3, v22
    v_and_b32 v21, 0xf0, v1
    v_or_b32 v22, v22, v21
    v_add_u32 v22, s25, v22
    v_add_u32 v117, s25, v1
    v_xor_b32 v84, 0, v22
    v_xor_b32 v85, 16, v22
    v_xor_b32 v86, 32, v22
    v_xor_b32 v87, 48, v22
    v_xor_b32 v88, 64, v22
    v_xor_b32 v89, 80, v22
    v_xor_b32 v90, 96, v22
    v_xor_b32 v91, 112, v22
    v_xor_b32 v92, 128, v22
    v_xor_b32 v93, 144, v22
    v_xor_b32 v94, 160, v22
    v_xor_b32 v95, 176, v22
    v_xor_b32 v96, 192, v22
    v_xor_b32 v97, 208, v22
    v_xor_b32 v98, 224, v22
    v_xor_b32 v99, 240, v22
    s_mul_i32 s23, s46, 768
    s_add_u32 s23, s23, 157184
    v_lshrrev_b32 v120, 2, v1
    v_add_u32 v121, 157184, v120
    v_add_u32 v120, s23, v120
    v_bfe_u32 v113, v1, 6, 2
    v_lshl_add_u32 v113, v3, 2, v113
    v_lshlrev_b32 v113, 7, v113
    v_bfe_u32 v18, v1, 8, 1
    v_lshl_add_u32 v113, v18, 5, v113
    v_bfe_u32 v18, v1, 4, 2
    v_lshl_add_u32 v113, v18, 3, v113
    v_lshrrev_b32 v18, 1, v1
    v_and_b32 v18, 64, v18
    s_and_b32 s23, s46, 2
    s_lshl_b32 s23, s23, 5
    v_xor_b32 v18, s23, v18
    v_add_u32 v113, v113, v18
    v_mov_b32 v32, 0
    v_mov_b32 v33, 0
    v_mov_b32 v34, 0
    v_mov_b32 v35, 0
    v_mov_b32 v36, 0
    v_mov_b32 v37, 0
    v_mov_b32 v38, 0
    v_mov_b32 v39, 0
    v_mov_b32 v40, 0
    v_mov_b32 v41, 0
    v_mov_b32 v42, 0
    v_mov_b32 v43, 0
    s_mov_b32 s39, 0x3f803f80
    s_and_b32 s36, s46, 1
    s_lshl_b32 s23, s36, 15
    s_add_u32 s23, s23, 65536
    v_add_u32 v112, s23, v1
    v_lshlrev_b32 v7, 2, v2
    s_lshl_b32 s38, s36, 8
    s_add_u32 s38, s38, 155648
    v_add_u32 v7, s38, v7
    s_lshl_b32 s22, s46, 11
    s_add_u32 s22, s22, 147456
    v_add_u32 v118, s22, v1
    s_lshl_b32 s23, s36, 2
    v_add_u32 v119, s23, v123
    s_waitcnt lgkmcnt(0)
    s_add_u32 s62, s58, 64
    s_xor_b32 s63, s62, 0x5a3c96e1
    s_barrier
    s_waitcnt vmcnt(0)
L_cw_21:
    ds_read_b32 v4, v123 offset:24
    s_waitcnt lgkmcnt(0)
    v_readfirstlane_b32 s22, v4
    s_nop 0
    s_cmp_lt_u32 s22, 3
    s_cbranch_scc1 L_cw_21
    s_lshl_b32 s22, s27, 15
    s_add_u32 s22, s22, s28
    s_lshl_b32 s23, s27, 12
    s_add_u32 s23, s23, s26
    s_add_u32 s27, s27, 1
    s_and_b32 s27, s27, 3
    s_mov_b32 m0, s23
    s_add_u32 s23, s23, 1024
    buffer_load_dwordx4 v24, s[80:83], s22 offen lds
    s_add_u32 s22, s22, 8192
    s_mov_b32 m0, s23
    s_add_u32 s23, s23, 1024
    buffer_load_dwordx4 v24, s[80:83], s22 offen lds
    s_add_u32 s22, s22, 8192
    s_mov_b32 m0, s23
    s_add_u32 s23, s23, 1024
    buffer_load_dwordx4 v24, s[80:83], s22 offen lds
    s_add_u32 s22, s22, 8192
    s_mov_b32 m0, s23
    s_add_u32 s23, s23, 1024
    buffer_load_dwordx4 v24, s[80:83], s22 offen lds
    s_add_u32 s22, s22, 8192
    s_lshl_b32 s22, s27, 15
    s_add_u32 s22, s22, s28
    s_lshl_b32 s23, s27, 12
    s_add_u32 s23, s23, s26
    s_add_u32 s27, s27, 1
    s_and_b32 s27, s27, 3
    s_mov_b32 m0, s23
    s_add_u32 s23, s23, 1024
    buffer_load_dwordx4 v24, s[80:83], s22 offen lds
    s_add_u32 s22, s22, 8192
    s_mov_b32 m0, s23
    s_add_u32 s23, s23, 1024
    buffer_load_dwordx4 v24, s[80:83], s22 offen lds
    s_add_u32 s22, s22, 8192
    s_mov_b32 m0, s23
    s_add_u32 s23, s23, 1024
    buffer_load_dwordx4 v24, s[80:83], s22 offen lds
    s_add_u32 s22, s22, 8192
    s_mov_b32 m0, s23
    s_add_u32 s23, s23, 1024
    buffer_load_dwordx4 v24, s[80:83], s22 offen lds
    s_add_u32 s22, s22, 8192
    s_lshl_b32 s22, s27, 15
    s_add_u32 s22, s22, s28
    s_lshl_b32 s23, s27, 12
    s_add_u32 s23, s23, s26
    s_add_u32 s27, s27, 1
    s_and_b32 s27, s27, 3
    s_mov_b32 m0, s23
    s_add_u32 s23, s23, 1024
    buffer_load_dwordx4 v24, s[80:83], s22 offen lds
    s_add_u32 s22, s22, 8192
    s_mov_b32 m0, s23
    s_add_u32 s23, s23, 1024
    buffer_load_dwordx4 v24, s[80:83], s22 offen lds
    s_add_u32 s22, s22, 8192
    s_mov_b32 m0, s23
    s_add_u32 s23, s23, 1024
    buffer_load_dwordx4 v24, s[80:83], s22 offen lds
    s_add_u32 s22, s22, 8192
    s_mov_b32 m0, s23
    s_add_u32 s23, s23, 1024
    buffer_load_dwordx4 v24, s[80:83], s22 offen lds
    s_add_u32 s22, s22, 8192
    s_mov_b32 s23, s25
    s_mov_b32 m0, s23
    s_add_u32 s23, s23, 1024
    buffer_load_dwordx4 v80, s[64:67], s24 offen lds
    s_add_u32 s24, s24, 4096
    s_mov_b32 m0, s23
    s_add_u32 s23, s23, 1024
    buffer_load_dwordx4 v81, s[64:67], s24 offen lds
    s_add_u32 s24, s24, 4096
    s_mov_b32 m0, s23
    s_add_u32 s23, s23, 1024
    buffer_load_dwordx4 v82, s[64:67], s24 offen lds
    s_add_u32 s24, s24, 4096
    s_mov_b32 m0, s23
    s_add_u32 s23, s23, 1024
    buffer_load_dwordx4 v83, s[64:67], s24 offen lds
    s_add_u32 s24, s24, 4096
    s_mov_b32 m0, s23
    s_add_u32 s23, s23, 1024
    buffer_load_dwordx4 v80, s[64:67], s24 offen lds
    s_add_u32 s24, s24, 4096
    s_mov_b32 m0, s23
    s_add_u32 s23, s23, 1024
    buffer_load_dwordx4 v81, s[64:67], s24 offen lds
    s_add_u32 s24, s24, 4096
    s_mov_b32 m0, s23
    s_add_u32 s23, s23, 1024
    buffer_load_dwordx4 v82, s[64:67], s24 offen lds
    s_add_u32 s24, s24, 4096
    s_mov_b32 m0, s23
    s_add_u32 s23, s23, 1024
    buffer_load_dwordx4 v83, s[64:67], s24 offen lds
    s_add_u32 s24, s24, 4096
    s_waitcnt vmcnt(8)
    s_mov_b64 exec, 1
    ds_add_u32 v123, v122 offset:60
    s_mov_b64 exec, -1
L_cw_22:
    ds_read_b32 v4, v123 offset:60
    s_waitcnt lgkmcnt(0)
    v_readfirstlane_b32 s22, v4
    s_nop 0
    s_cmp_lt_u32 s22, 4
    s_cbranch_scc1 L_cw_22
    ds_read_b64_tr_b16 v[128:129], v113 offset:0
    ds_read_b64_tr_b16 v[130:131], v113 offset:1024
    ds_read_b64_tr_b16 v[132:133], v113 offset:2048
    ds_read_b64_tr_b16 v[134:135], v113 offset:3072
    ds_read_b64_tr_b16 v[136:137], v113 offset:4096
    ds_read_b64_tr_b16 v[138:139], v113 offset:5120
    ds_read_b64_tr_b16 v[140:141], v113 offset:6144
    ds_read_b64_tr_b16 v[142:143], v113 offset:7168
    ds_read_b64_tr_b16 v[144:145], v113 offset:8192
    ds_read_b64_tr_b16 v[146:147], v113 offset:9216
    ds_read_b64_tr_b16 v[148:149], v113 offset:10240
    ds_read_b64_tr_b16 v[150:151], v113 offset:11264
    ds_read_b64_tr_b16 v[152:153], v113 offset:12288
    ds_read_b64_tr_b16 v[154:155], v113 offset:13312
    ds_read_b64_tr_b16 v[156:157], v113 offset:14336
    ds_read_b64_tr_b16 v[158:159], v113 offset:15360
    ds_read_b64_tr_b16 v[160:161], v113 offset:16384
    ds_read_b64_tr_b16 v[162:163], v113 offset:17408
    ds_read_b64_tr_b16 v[164:165], v113 offset:18432
    ds_read_b64_tr_b16 v[166:167], v113 offset:19456
    ds_read_b64_tr_b16 v[168:169], v113 offset:20480
    ds_read_b64_tr_b16 v[170:171], v113 offset:21504
    ds_read_b64_tr_b16 v[172:173], v113 offset:22528
    ds_read_b64_tr_b16 v[174:175], v113 offset:23552
    ds_read_b64_tr_b16 v[176:177], v113 offset:24576
    ds_read_b64_tr_b16 v[178:179], v113 offset:25600
    ds_read_b64_tr_b16 v[180:181], v113 offset:26624
    ds_read_b64_tr_b16 v[182:183], v113 offset:27648
    ds_read_b64_tr_b16 v[184:185], v113 offset:28672
    ds_read_b64_tr_b16 v[186:187], v113 offset:29696
    ds_read_b64_tr_b16 v[188:189], v113 offset:30720
    ds_read_b64_tr_b16 v[190:191], v113 offset:31744
    ds_read_b64_tr_b16 v[192:193], v113 offset:32768
    ds_read_b64_tr_b16 v[194:195], v113 offset:33792
    ds_read_b64_tr_b16 v[196:197], v113 offset:34816
    ds_read_b64_tr_b16 v[198:199], v113 offset:35840
    ds_read_b64_tr_b16 v[200:201], v113 offset:36864
    ds_read_b64_tr_b16 v[202:203], v113 offset:37888
    ds_read_b64_tr_b16 v[204:205], v113 offset:38912
    ds_read_b64_tr_b16 v[206:207], v113 offset:39936
    ds_read_b64_tr_b16 v[208:209], v113 offset:40960
    ds_read_b64_tr_b16 v[210:211], v113 offset:41984
    ds_read_b64_tr_b16 v[212:213], v113 offset:43008
    ds_read_b64_tr_b16 v[214:215], v113 offset:44032
    ds_read_b64_tr_b16 v[216:217], v113 offset:45056
    ds_read_b64_tr_b16 v[218:219], v113 offset:46080
    ds_read_b64_tr_b16 v[220:221], v113 offset:47104
    ds_read_b64_tr_b16 v[222:223], v113 offset:48128
    ds_read_b64_tr_b16 v[224:225], v113 offset:49152
    ds_read_b64_tr_b16 v[226:227], v113 offset:50176
    ds_read_b64_tr_b16 v[228:229], v113 offset:51200
    ds_read_b64_tr_b16 v[230:231], v113 offset:52224
    ds_read_b64_tr_b16 v[232:233], v113 offset:53248
    ds_read_b64_tr_b16 v[234:235], v113 offset:54272
    ds_read_b64_tr_b16 v[236:237], v113 offset:55296
    ds_read_b64_tr_b16 v[238:239], v113 offset:56320
    ds_read_b64_tr_b16 v[240:241], v113 offset:57344
    ds_read_b64_tr_b16 v[242:243], v113 offset:58368
    ds_read_b64_tr_b16 v[244:245], v113 offset:59392
    ds_read_b64_tr_b16 v[246:247], v113 offset:60416
    ds_read_b64_tr_b16 v[248:249], v113 offset:61440
    ds_read_b64_tr_b16 v[250:251], v113 offset:62464
    ds_read_b64_tr_b16 v[252:253], v113 offset:63488
    ds_read_b64_tr_b16 v[254:255], v113 offset:64512
    s_mov_b64 exec, 1
    ds_add_u32 v123, v122 offset:56
    s_mov_b64 exec, -1
    s_waitcnt vmcnt(0)
    ds_read_b64 v[48:49], v84
    ds_read_b64 v[50:51], v85
    ds_read_b64 v[52:53], v86
    ds_read_b64 v[54:55], v87
    ds_read_b64 v[56:57], v88
    ds_read_b64 v[58:59], v89
    ds_read_b64 v[60:61], v90
    ds_read_b64 v[62:63], v91
    ds_read_b64 v[64:65], v92
    ds_read_b64 v[66:67], v93
    ds_read_b64 v[68:69], v94
    ds_read_b64 v[70:71], v95
    ds_read_b64 v[72:73], v96
    ds_read_b64 v[74:75], v97
    ds_read_b64 v[76:77], v98
    ds_read_b64 v[78:79], v99
    s_lshl_b32 s23, s46, 7
    s_add_u32 s23, s23, 156160
    v_lshlrev_b32 v16, 2, v2
    v_add_u32 v16, s23, v16
    s_and_b32 s23, s23, 0xffffff7f
    v_lshlrev_b32 v17, 4, v3
    v_add_u32 v17, s23, v17
    s_waitcnt lgkmcnt(0)
    ds_write_b128 v117, v[48:51] offset:0
    ds_write_b128 v117, v[52:55] offset:1024
    ds_write_b128 v117, v[56:59] offset:2048
    ds_write_b128 v117, v[60:63] offset:3072
    ds_write_b128 v117, v[64:67] offset:4096
    ds_write_b128 v117, v[68:71] offset:5120
    ds_write_b128 v117, v[72:75] offset:6144
    ds_write_b128 v117, v[76:79] offset:7168
    v_dot2_f32_bf16 v32, v48, s39, v32
    v_dot2_f32_bf16 v36, v48, v48, v36
    v_dot2_f32_bf16 v33, v49, s39, v33
    v_dot2_f32_bf16 v37, v49, v49, v37
    v_dot2_f32_bf16 v34, v50, s39, v34
    v_dot2_f32_bf16 v38, v50, v50, v38
    v_dot2_f32_bf16 v35, v51, s39, v35
    v_dot2_f32_bf16 v39, v51, v51, v39
    v_dot2_f32_bf16 v32, v52, s39, v32
    v_dot2_f32_bf16 v36, v52, v52, v36
    v_dot2_f32_bf16 v33, v53, s39, v33
    v_dot2_f32_bf16 v37, v53, v53, v37
    v_dot2_f32_bf16 v34, v54, s39, v34
    v_dot2_f32_bf16 v38, v54, v54, v38
    v_dot2_f32_bf16 v35, v55, s39, v35
    v_dot2_f32_bf16 v39, v55, v55, v39
    v_dot2_f32_bf16 v32, v56, s39, v32
    v_dot2_f32_bf16 v36, v56, v56, v36
    v_dot2_f32_bf16 v33, v57, s39, v33
    v_dot2_f32_bf16 v37, v57, v57, v37
    v_dot2_f32_bf16 v34, v58, s39, v34
    v_dot2_f32_bf16 v38, v58, v58, v38
    v_dot2_f32_bf16 v35, v59, s39, v35
    v_dot2_f32_bf16 v39, v59, v59, v39
    v_dot2_f32_bf16 v32, v60, s39, v32
    v_dot2_f32_bf16 v36, v60, v60, v36
    v_dot2_f32_bf16 v33, v61, s39, v33
    v_dot2_f32_bf16 v37, v61, v61, v37
    v_dot2_f32_bf16 v34, v62, s39, v34
    v_dot2_f32_bf16 v38, v62, v62, v38
    v_dot2_f32_bf16 v35, v63, s39, v35
    v_dot2_f32_bf16 v39, v63, v63, v39
    v_dot2_f32_bf16 v32, v64, s39, v32
    v_dot2_f32_bf16 v36, v64, v64, v36
    v_dot2_f32_bf16 v33, v65, s39, v33
    v_dot2_f32_bf16 v37, v65, v65, v37
    v_dot2_f32_bf16 v34, v66, s39, v34
    v_dot2_f32_bf16 v38, v66, v66, v38
    v_dot2_f32_bf16 v35, v67, s39, v35
    v_dot2_f32_bf16 v39, v67, v67, v39
    v_dot2_f32_bf16 v32, v68, s39, v32
    v_dot2_f32_bf16 v36, v68, v68, v36
    v_dot2_f32_bf16 v33, v69, s39, v33
    v_dot2_f32_bf16 v37, v69, v69, v37
    v_dot2_f32_bf16 v34, v70, s39, v34
    v_dot2_f32_bf16 v38, v70, v70, v38
    v_dot2_f32_bf16 v35, v71, s39, v35
    v_dot2_f32_bf16 v39, v71, v71, v39
    v_dot2_f32_bf16 v32, v72, s39, v32
    v_dot2_f32_bf16 v36, v72, v72, v36
    v_dot2_f32_bf16 v33, v73, s39, v33
    v_dot2_f32_bf16 v37, v73, v73, v37
    v_dot2_f32_bf16 v34, v74, s39, v34
    v_dot2_f32_bf16 v38, v74, v74, v38
    v_dot2_f32_bf16 v35, v75, s39, v35
    v_dot2_f32_bf16 v39, v75, v75, v39
    v_dot2_f32_bf16 v32, v76, s39, v32
    v_dot2_f32_bf16 v36, v76, v76, v36
    v_dot2_f32_bf16 v33, v77, s39, v33
    v_dot2_f32_bf16 v37, v77, v77, v37
    v_dot2_f32_bf16 v34, v78, s39, v34
    v_dot2_f32_bf16 v38, v78, v78, v38
    v_dot2_f32_bf16 v35, v79, s39, v35
    v_dot2_f32_bf16 v39, v79, v79, v39
    s_cmp_eq_u32 s36, 1
    s_cbranch_scc1 L_st_d_23
    v_dot2_f32_bf16 v40, v128, s39, v40
    v_dot2_f32_bf16 v41, v129, s39, v41
    v_dot2_f32_bf16 v42, v130, s39, v42
    v_dot2_f32_bf16 v43, v131, s39, v43
    v_dot2_f32_bf16 v40, v132, s39, v40
    v_dot2_f32_bf16 v41, v133, s39, v41
    v_dot2_f32_bf16 v42, v134, s39, v42
    v_dot2_f32_bf16 v43, v135, s39, v43
    v_dot2_f32_bf16 v40, v136, s39, v40
    v_dot2_f32_bf16 v41, v137, s39, v41
    v_dot2_f32_bf16 v42, v138, s39, v42
    v_dot2_f32_bf16 v43, v139, s39, v43
    v_dot2_f32_bf16 v40, v140, s39, v40
    v_dot2_f32_bf16 v41, v141, s39, v41
    v_dot2_f32_bf16 v42, v142, s39, v42
    v_dot2_f32_bf16 v43, v143, s39, v43
    v_dot2_f32_bf16 v40, v144, s39, v40
    v_dot2_f32_bf16 v41, v145, s39, v41
    v_dot2_f32_bf16 v42, v146, s39, v42
    v_dot2_f32_bf16 v43, v147, s39, v43
    v_dot2_f32_bf16 v40, v148, s39, v40
    v_dot2_f32_bf16 v41, v149, s39, v41
    v_dot2_f32_bf16 v42, v150, s39, v42
    v_dot2_f32_bf16 v43, v151, s39, v43
    v_dot2_f32_bf16 v40, v152, s39, v40
    v_dot2_f32_bf16 v41, v153, s39, v41
    v_dot2_f32_bf16 v42, v154, s39, v42
    v_dot2_f32_bf16 v43, v155, s39, v43
    v_dot2_f32_bf16 v40, v156, s39, v40
    v_dot2_f32_bf16 v41, v157, s39, v41
    v_dot2_f32_bf16 v42, v158, s39, v42
    v_dot2_f32_bf16 v43, v159, s39, v43
    v_dot2_f32_bf16 v40, v160, s39, v40
    v_dot2_f32_bf16 v41, v161, s39, v41
    v_dot2_f32_bf16 v42, v162, s39, v42
    v_dot2_f32_bf16 v43, v163, s39, v43
    v_dot2_f32_bf16 v40, v164, s39, v40
    v_dot2_f32_bf16 v41, v165, s39, v41
    v_dot2_f32_bf16 v42, v166, s39, v42
    v_dot2_f32_bf16 v43, v167, s39, v43
    v_dot2_f32_bf16 v40, v168, s39, v40
    v_dot2_f32_bf16 v41, v169, s39, v41
    v_dot2_f32_bf16 v42, v170, s39, v42
    v_dot2_f32_bf16 v43, v171, s39, v43
    v_dot2_f32_bf16 v40, v172, s39, v40
    v_dot2_f32_bf16 v41, v173, s39, v41
    v_dot2_f32_bf16 v42, v174, s39, v42
    v_dot2_f32_bf16 v43, v175, s39, v43
    v_dot2_f32_bf16 v40, v176, s39, v40
    v_dot2_f32_bf16 v41, v177, s39, v41
    v_dot2_f32_bf16 v42, v178, s39, v42
    v_dot2_f32_bf16 v43, v179, s39, v43
    v_dot2_f32_bf16 v40, v180, s39, v40
    v_dot2_f32_bf16 v41, v181, s39, v41
    v_dot2_f32_bf16 v42, v182, s39, v42
    v_dot2_f32_bf16 v43, v183, s39, v43
    v_dot2_f32_bf16 v40, v184, s39, v40
    v_dot2_f32_bf16 v41, v185, s39, v41
    v_dot2_f32_bf16 v42, v186, s39, v42
    v_dot2_f32_bf16 v43, v187, s39, v43
    v_dot2_f32_bf16 v40, v188, s39, v40
    v_dot2_f32_bf16 v41, v189, s39, v41
    v_dot2_f32_bf16 v42, v190, s39, v42
    v_dot2_f32_bf16 v43, v191, s39, v43
    s_branch L_st_d_24
L_st_d_23:
    v_dot2_f32_bf16 v40, v192, s39, v40
    v_dot2_f32_bf16 v41, v193, s39, v41
    v_dot2_f32_bf16 v42, v194, s39, v42
    v_dot2_f32_bf16 v43, v195, s39, v43
    v_dot2_f32_bf16 v40, v196, s39, v40
    v_dot2_f32_bf16 v41, v197, s39, v41
    v_dot2_f32_bf16 v42, v198, s39, v42
    v_dot2_f32_bf16 v43, v199, s39, v43
    v_dot2_f32_bf16 v40, v200, s39, v40
    v_dot2_f32_bf16 v41, v201, s39, v41
    v_dot2_f32_bf16 v42, v202, s39, v42
    v_dot2_f32_bf16 v43, v203, s39, v43
    v_dot2_f32_bf16 v40, v204, s39, v40
    v_dot2_f32_bf16 v41, v205, s39, v41
    v_dot2_f32_bf16 v42, v206, s39, v42
    v_dot2_f32_bf16 v43, v207, s39, v43
    v_dot2_f32_bf16 v40, v208, s39, v40
    v_dot2_f32_bf16 v41, v209, s39, v41
    v_dot2_f32_bf16 v42, v210, s39, v42
    v_dot2_f32_bf16 v43, v211, s39, v43
    v_dot2_f32_bf16 v40, v212, s39, v40
    v_dot2_f32_bf16 v41, v213, s39, v41
    v_dot2_f32_bf16 v42, v214, s39, v42
    v_dot2_f32_bf16 v43, v215, s39, v43
    v_dot2_f32_bf16 v40, v216, s39, v40
    v_dot2_f32_bf16 v41, v217, s39, v41
    v_dot2_f32_bf16 v42, v218, s39, v42
    v_dot2_f32_bf16 v43, v219, s39, v43
    v_dot2_f32_bf16 v40, v220, s39, v40
    v_dot2_f32_bf16 v41, v221, s39, v41
    v_dot2_f32_bf16 v42, v222, s39, v42
    v_dot2_f32_bf16 v43, v223, s39, v43
    v_dot2_f32_bf16 v40, v224, s39, v40
    v_dot2_f32_bf16 v41, v225, s39, v41
    v_dot2_f32_bf16 v42, v226, s39, v42
    v_dot2_f32_bf16 v43, v227, s39, v43
    v_dot2_f32_bf16 v40, v228, s39, v40
    v_dot2_f32_bf16 v41, v229, s39, v41
    v_dot2_f32_bf16 v42, v230, s39, v42
    v_dot2_f32_bf16 v43, v231, s39, v43
    v_dot2_f32_bf16 v40, v232, s39, v40
    v_dot2_f32_bf16 v41, v233, s39, v41
    v_dot2_f32_bf16 v42, v234, s39, v42
    v_dot2_f32_bf16 v43, v235, s39, v43
    v_dot2_f32_bf16 v40, v236, s39, v40
    v_dot2_f32_bf16 v41, v237, s39, v41
    v_dot2_f32_bf16 v42, v238, s39, v42
    v_dot2_f32_bf16 v43, v239, s39, v43
    v_dot2_f32_bf16 v40, v240, s39, v40
    v_dot2_f32_bf16 v41, v241, s39, v41
    v_dot2_f32_bf16 v42, v242, s39, v42
    v_dot2_f32_bf16 v43, v243, s39, v43
    v_dot2_f32_bf16 v40, v244, s39, v40
    v_dot2_f32_bf16 v41, v245, s39, v41
    v_dot2_f32_bf16 v42, v246, s39, v42
    v_dot2_f32_bf16 v43, v247, s39, v43
    v_dot2_f32_bf16 v40, v248, s39, v40
    v_dot2_f32_bf16 v41, v249, s39, v41
    v_dot2_f32_bf16 v42, v250, s39, v42
    v_dot2_f32_bf16 v43, v251, s39, v43
    v_dot2_f32_bf16 v40, v252, s39, v40
    v_dot2_f32_bf16 v41, v253, s39, v41
    v_dot2_f32_bf16 v42, v254, s39, v42
    v_dot2_f32_bf16 v43, v255, s39, v43
L_st_d_24:
    v_add_f32 v32, v32, v33
    v_add_f32 v34, v34, v35
    v_add_f32 v36, v36, v37
    v_add_f32 v38, v38, v39
    v_add_f32 v32, v32, v34
    v_add_f32 v36, v36, v38
    s_nop 1
    v_permlane32_swap_b32 v32, v36
    v_add_f32 v32, v32, v36
    ds_write_b32 v120, v32 offset:512
    v_add_f32 v40, v40, v41
    v_add_f32 v42, v42, v43
    v_add_f32 v40, v40, v42
    v_mov_b32 v41, v40
    s_nop 1
    v_permlane32_swap_b32 v40, v41
    v_add_f32 v40, v40, v41
    ds_write_b32 v16, v40
    s_mov_b64 exec, 1
    ds_add_u32 v123, v122 offset:28
    s_mov_b64 exec, -1
L_cw_25:
    ds_read_b32 v4, v123 offset:28
    s_waitcnt lgkmcnt(0)
    v_readfirstlane_b32 s22, v4
    s_nop 0
    s_cmp_lt_u32 s22, 4
    s_cbranch_scc1 L_cw_25
    ds_read_b128 v[96:99], v17 offset:0
    ds_read_b128 v[80:83], v17 offset:128
    ds_read_b128 v[100:103], v17 offset:32
    ds_read_b128 v[84:87], v17 offset:160
    ds_read_b128 v[104:107], v17 offset:64
    ds_read_b128 v[88:91], v17 offset:192
    ds_read_b128 v[108:111], v17 offset:96
    ds_read_b128 v[92:95], v17 offset:224
    ds_read2st64_b32 v[32:33], v121 offset0:2 offset1:5
    ds_read2st64_b32 v[34:35], v121 offset0:8 offset1:11
    s_waitcnt lgkmcnt(0)
    v_add_f32 v96, v96, v80
    v_add_f32 v97, v97, v81
    v_add_f32 v98, v98, v82
    v_add_f32 v99, v99, v83
    v_add_f32 v100, v100, v84
    v_add_f32 v101, v101, v85
    v_add_f32 v102, v102, v86
    v_add_f32 v103, v103, v87
    v_add_f32 v104, v104, v88
    v_add_f32 v105, v105, v89
    v_add_f32 v106, v106, v90
    v_add_f32 v107, v107, v91
    v_add_f32 v108, v108, v92
    v_add_f32 v109, v109, v93
    v_add_f32 v110, v110, v94
    v_add_f32 v111, v111, v95
    s_xor_b32 s23, s36, s17
    s_bitcmp1_b32 s23, 0
    s_cbranch_scc1 L_st_oth_26
L_cw_27:
    ds_read_b32 v4, v119 offset:48
    s_waitcnt lgkmcnt(0)
    v_readfirstlane_b32 s22, v4
    s_nop 0
    s_cmp_lt_u32 s22, 4
    s_cbranch_scc1 L_cw_27
    s_branch L_qa_gemm
L_st_oth_26:
    v_add_f32 v32, v32, v33
    v_add_f32 v34, v34, v35
    v_add_f32 v32, v32, v34
    v_mul_f32 v114, 0x3b000000, v32
    s_nop 0
    v_mov_b32 v115, v114
    s_nop 1
    v_permlane32_swap_b32 v114, v115
    v_fma_f32 v115, -v114, v114, v115
    v_max_f32 v115, 0, v115
    v_add_f32 v115, 0x3727c5ac, v115
    v_rsq_f32 v115, v115
    s_branch L_qa_gemm2
L_iter:
    v_add_u32 v112, 32768, v1
    s_cmp_lt_u32 s3, 4
    s_cbranch_scc1 L_qa_L_28
    s_lshl_b32 s38, s47, 7
    s_add_u32 s38, s38, 3211264
    v_lshlrev_b32 v4, 4, v3
    buffer_load_dwordx4 v[96:99], v4, s[8:11], s38 offen offset:0 sc1
    buffer_load_dwordx4 v[100:103], v4, s[8:11], s38 offen offset:32 sc1
    buffer_load_dwordx4 v[104:107], v4, s[8:11], s38 offen offset:64 sc1
    buffer_load_dwordx4 v[108:111], v4, s[8:11], s38 offen offset:96 sc1
    v_lshlrev_b32 v7, 2, v2
    v_add_u32 v7, 155648, v7
    s_lshl_b32 s22, s46, 11
    s_add_u32 s22, s22, 147456
    v_add_u32 v118, s22, v1
    s_lshl_b32 s22, s18, 15
    s_lshl_b32 s23, s46, 13
    s_add_u32 s22, s22, s23
    s_add_u32 s22, s22, 4194304
    s_add_u32 s23, s23, 32768
    s_lshl_b32 s24, s18, 12
    s_add_u32 s24, s24, 3407872
    v_lshrrev_b32 v6, 2, v1
    s_lshl_b32 s39, s20, 2
    s_add_u32 s39, s39, 0
    s_bitcmp1_b32 s17, 0
    s_mov_b32 s42, 0xf000f
    s_cselect_b32 s42, 0xf000f00, s42
    s_mov_b32 s43, s42
    s_lshl_b32 s38, s46, 4
    s_lshl_b64 s[40:41], 0xffff, s38
    s_and_b64 s[42:43], s[42:43], s[40:41]
    s_lshl_b32 s38, s17, 3
    s_lshl_b64 s[40:41], 0xf, s38
    s_or_b64 s[42:43], s[42:43], s[40:41]
    v_lshrrev_b32 v4, 2, v1
    s_mov_b32 s40, 400000
    s_mov_b64 exec, s[42:43]
L_poll_30:
    buffer_load_dword v5, v4, s[8:11], s57 offen offset:0 sc1
    s_waitcnt vmcnt(0)
    v_cmp_gt_u32 vcc, s39, v5
    s_cbranch_vccz L_polled_31
    s_sleep 1
    s_sub_u32 s40, s40, 1
    s_cmp_lg_u32 s40, 0
    s_cbranch_scc1 L_poll_30
L_polled_31:
    s_mov_b64 exec, -1
    s_mov_b32 m0, s23
    s_nop 0
    buffer_load_dwordx4 v1, s[8:11], s22 offen offset:0 sc1 lds
    buffer_load_dwordx4 v1, s[8:11], s22 offen offset:1024 sc1 lds
    buffer_load_dwordx4 v1, s[8:11], s22 offen offset:2048 sc1 lds
    buffer_load_dwordx4 v1, s[8:11], s22 offen offset:3072 sc1 lds
    s_add_u32 s22, s22, 4096
    s_add_u32 s23, s23, 4096
    s_mov_b32 m0, s23
    s_nop 0
    buffer_load_dwordx4 v1, s[8:11], s22 offen offset:0 sc1 lds
    buffer_load_dwordx4 v1, s[8:11], s22 offen offset:1024 sc1 lds
    buffer_load_dwordx4 v1, s[8:11], s22 offen offset:2048 sc1 lds
    buffer_load_dwordx4 v1, s[8:11], s22 offen offset:3072 sc1 lds
    s_cmp_eq_u32 s46, s19
    s_cbranch_scc1 L_qa_st_32
    s_waitcnt vmcnt(0)
    s_barrier
L_qa_st_33:
    s_barrier
    s_barrier
    buffer_load_dwordx4 v[192:195], v1, s[8:11], s52 offen offset:0 sc1
    buffer_load_dwordx4 v[196:199], v1, s[8:11], s52 offen offset:1024 sc1
    buffer_load_dwordx4 v[200:203], v1, s[8:11], s52 offen offset:2048 sc1
    buffer_load_dwordx4 v[204:207], v1, s[8:11], s52 offen offset:3072 sc1
    buffer_load_dwordx4 v[208:211], v1, s[8:11], s53 offen offset:0 sc1
    buffer_load_dwordx4 v[212:215], v1, s[8:11], s53 offen offset:1024 sc1
    buffer_load_dwordx4 v[216:219], v1, s[8:11], s53 offen offset:2048 sc1
    buffer_load_dwordx4 v[220:223], v1, s[8:11], s53 offen offset:3072 sc1
    buffer_load_dwordx4 v[224:227], v1, s[8:11], s54 offen offset:0 sc1
    buffer_load_dwordx4 v[228:231], v1, s[8:11], s54 offen offset:1024 sc1
    buffer_load_dwordx4 v[232:235], v1, s[8:11], s54 offen offset:2048 sc1
    buffer_load_dwordx4 v[236:239], v1, s[8:11], s54 offen offset:3072 sc1
    buffer_load_dwordx4 v[240:243], v1, s[8:11], s55 offen offset:0 sc1
    buffer_load_dwordx4 v[244:247], v1, s[8:11], s55 offen offset:1024 sc1
    buffer_load_dwordx4 v[248:251], v1, s[8:11], s55 offen offset:2048 sc1
    buffer_load_dwordx4 v[252:255], v1, s[8:11], s55 offen offset:3072 sc1
    s_waitcnt vmcnt(0)
L_qa_gemm:
    ds_read2_b32 v[114:115], v7 offset0:0 offset1:32
L_qa_gemm2:
    ds_read_b128 v[48:51], v112 offset:0
    ds_read_b128 v[52:55], v112 offset:1024
    ds_read_b128 v[56:59], v112 offset:2048
    ds_read_b128 v[60:63], v112 offset:3072
    ds_read_b128 v[64:67], v112 offset:4096
    ds_read_b128 v[68:71], v112 offset:5120
    ds_read_b128 v[72:75], v112 offset:6144
    ds_read_b128 v[76:79], v112 offset:7168
    s_waitcnt lgkmcnt(7)
    v_mfma_f32_32x32x16_bf16 v[16:31], v[128:131], v[48:51], 0
    ds_read_b128 v[48:51], v112 offset:8192
    s_waitcnt lgkmcnt(7)
    v_mfma_f32_32x32x16_bf16 v[16:31], v[132:135], v[52:55], v[16:31]
    ds_read_b128 v[52:55], v112 offset:9216
    s_waitcnt lgkmcnt(7)
    v_mfma_f32_32x32x16_bf16 v[16:31], v[136:139], v[56:59], v[16:31]
    ds_read_b128 v[56:59], v112 offset:10240
    s_waitcnt lgkmcnt(7)
    v_mfma_f32_32x32x16_bf16 v[16:31], v[140:143], v[60:63], v[16:31]
    ds_read_b128 v[60:63], v112 offset:11264
    s_waitcnt lgkmcnt(7)
    v_mfma_f32_32x32x16_bf16 v[16:31], v[144:147], v[64:67], v[16:31]
    ds_read_b128 v[64:67], v112 offset:12288
    s_waitcnt lgkmcnt(7)
    v_mfma_f32_32x32x16_bf16 v[16:31], v[148:151], v[68:71], v[16:31]
    ds_read_b128 v[68:71], v112 offset:13312
    s_waitcnt lgkmcnt(7)
    v_mfma_f32_32x32x16_bf16 v[16:31], v[152:155], v[72:75], v[16:31]
    ds_read_b128 v[72:75], v112 offset:14336
    s_waitcnt lgkmcnt(7)
    v_mfma_f32_32x32x16_bf16 v[16:31], v[156:159], v[76:79], v[16:31]
    ds_read_b128 v[76:79], v112 offset:15360
    s_waitcnt lgkmcnt(7)
    v_mfma_f32_32x32x16_bf16 v[16:31], v[160:163], v[48:51], v[16:31]
    ds_read_b128 v[48:51], v112 offset:16384
    s_waitcnt lgkmcnt(7)
    v_mfma_f32_32x32x16_bf16 v[16:31], v[164:167], v[52:55], v[16:31]
    ds_read_b128 v[52:55], v112 offset:17408
    s_waitcnt lgkmcnt(7)
    v_mfma_f32_32x32x16_bf16 v[16:31], v[168:171], v[56:59], v[16:31]
    ds_read_b128 v[56:59], v112 offset:18432
    s_waitcnt lgkmcnt(7)
    v_mfma_f32_32x32x16_bf16 v[16:31], v[172:175], v[60:63], v[16:31]
    ds_read_b128 v[60:63], v112 offset:19456
    s_waitcnt lgkmcnt(7)
    v_mfma_f32_32x32x16_bf16 v[16:31], v[176:179], v[64:67], v[16:31]
    ds_read_b128 v[64:67], v112 offset:20480
    s_waitcnt lgkmcnt(7)
    v_mfma_f32_32x32x16_bf16 v[16:31], v[180:183], v[68:71], v[16:31]
    ds_read_b128 v[68:71], v112 offset:21504
    s_waitcnt lgkmcnt(7)
    v_mfma_f32_32x32x16_bf16 v[16:31], v[184:187], v[72:75], v[16:31]
    ds_read_b128 v[72:75], v112 offset:22528
    s_waitcnt lgkmcnt(7)
    v_mfma_f32_32x32x16_bf16 v[16:31], v[188:191], v[76:79], v[16:31]
    ds_read_b128 v[76:79], v112 offset:23552
    s_waitcnt lgkmcnt(7)
    v_mfma_f32_32x32x16_bf16 v[16:31], v[192:195], v[48:51], v[16:31]
    ds_read_b128 v[48:51], v112 offset:24576
    s_waitcnt lgkmcnt(7)
    v_mfma_f32_32x32x16_bf16 v[16:31], v[196:199], v[52:55], v[16:31]
    ds_read_b128 v[52:55], v112 offset:25600
    s_waitcnt lgkmcnt(7)
    v_mfma_f32_32x32x16_bf16 v[16:31], v[200:203], v[56:59], v[16:31]
    ds_read_b128 v[56:59], v112 offset:26624
    s_waitcnt lgkmcnt(7)
    v_mfma_f32_32x32x16_bf16 v[16:31], v[204:207], v[60:63], v[16:31]
    ds_read_b128 v[60:63], v112 offset:27648
    s_waitcnt lgkmcnt(7)
    v_mfma_f32_32x32x16_bf16 v[16:31], v[208:211], v[64:67], v[16:31]
    ds_read_b128 v[64:67], v112 offset:28672
    s_waitcnt lgkmcnt(7)
    v_mfma_f32_32x32x16_bf16 v[16:31], v[212:215], v[68:71], v[16:31]
    ds_read_b128 v[68:71], v112 offset:29696
    s_waitcnt lgkmcnt(7)
    v_mfma_f32_32x32x16_bf16 v[16:31], v[216:219], v[72:75], v[16:31]
    ds_read_b128 v[72:75], v112 offset:30720
    s_waitcnt lgkmcnt(7)
    v_mfma_f32_32x32x16_bf16 v[16:31], v[220:223], v[76:79], v[16:31]
    ds_read_b128 v[76:79], v112 offset:31744
    s_waitcnt lgkmcnt(7)
    v_mfma_f32_32x32x16_bf16 v[16:31], v[224:227], v[48:51], v[16:31]
    s_waitcnt lgkmcnt(6)
    v_mfma_f32_32x32x16_bf16 v[16:31], v[228:231], v[52:55], v[16:31]
    s_waitcnt lgkmcnt(5)
    v_mfma_f32_32x32x16_bf16 v[16:31], v[232:235], v[56:59], v[16:31]
    s_waitcnt lgkmcnt(4)
    v_mfma_f32_32x32x16_bf16 v[16:31], v[236:239], v[60:63], v[16:31]
    s_waitcnt lgkmcnt(3)
    v_mfma_f32_32x32x16_bf16 v[16:31], v[240:243], v[64:67], v[16:31]
    s_waitcnt lgkmcnt(2)
    v_mfma_f32_32x32x16_bf16 v[16:31], v[244:247], v[68:71], v[16:31]
    s_waitcnt lgkmcnt(1)
    v_mfma_f32_32x32x16_bf16 v[16:31], v[248:251], v[72:75], v[16:31]
    s_waitcnt lgkmcnt(0)
    v_mfma_f32_32x32x16_bf16 v[16:31], v[252:255], v[76:79], v[16:31]
    s_nop 10
    v_mul_f32 v115, 0x3eb8aa3b, v115
    v_fma_f32 v16, -v114, v96, v16
    v_fma_f32 v17, -v114, v97, v17
    v_fma_f32 v18, -v114, v98, v18
    v_fma_f32 v19, -v114, v99, v19
    v_fma_f32 v20, -v114, v100, v20
    v_fma_f32 v21, -v114, v101, v21
    v_fma_f32 v22, -v114, v102, v22
    v_fma_f32 v23, -v114, v103, v23
    v_fma_f32 v24, -v114, v104, v24
    v_fma_f32 v25, -v114, v105, v25
    v_fma_f32 v26, -v114, v106, v26
    v_fma_f32 v27, -v114, v107, v27
    v_fma_f32 v28, -v114, v108, v28
    v_fma_f32 v29, -v114, v109, v29
    v_fma_f32 v30, -v114, v110, v30
    v_fma_f32 v31, -v114, v111, v31
    v_mul_f32 v16, v115, v16
    v_mul_f32 v17, v115, v17
    v_mul_f32 v18, v115, v18
    v_mul_f32 v19, v115, v19
    v_mul_f32 v20, v115, v20
    v_mul_f32 v21, v115, v21
    v_mul_f32 v22, v115, v22
    v_mul_f32 v23, v115, v23
    v_mul_f32 v24, v115, v24
    v_mul_f32 v25, v115, v25
    v_mul_f32 v26, v115, v26
    v_mul_f32 v27, v115, v27
    v_mul_f32 v28, v115, v28
    v_mul_f32 v29, v115, v29
    v_mul_f32 v30, v115, v30
    v_mul_f32 v31, v115, v31
    v_cvt_pk_bf16_f32 v16, v16, v17
    v_cvt_pk_bf16_f32 v17, v18, v19
    v_cvt_pk_bf16_f32 v18, v20, v21
    v_cvt_pk_bf16_f32 v19, v22, v23
    v_cvt_pk_bf16_f32 v20, v24, v25
    v_cvt_pk_bf16_f32 v21, v26, v27
    v_cvt_pk_bf16_f32 v22, v28, v29
    v_cvt_pk_bf16_f32 v23, v30, v31
    ds_write_b128 v118, v[16:19]
    ds_write_b128 v118, v[20:23] offset:1024
    s_branch L_qa_end_29
L_qa_L_28:
    s_lshl_b32 s23, s46, 13
    v_add_u32 v112, s23, v112
    s_add_u32 s23, s23, 114688
    v_add_u32 v113, s23, v1
    s_mul_i32 s23, s46, 4608
    s_add_u32 s23, s23, 93696
    v_add_u32 v119, s23, v1
    s_cmp_ge_u32 s19, 2
    s_cbranch_scc1 L_qa_idle_36
    s_mov_b32 s25, 16
    s_lshr_b32 s26, s18, 3
    s_lshl_b32 s27, s26, 14
    s_and_b32 s23, s18, 3
    s_lshl_b32 s23, s23, 12
    s_add_u32 s27, s27, s23
    s_and_b32 s23, s18, 4
    s_lshl_b32 s23, s23, 9
    s_add_u32 s27, s27, s23
    s_add_u32 s27, s27, s21
    s_add_u32 s27, s27, 16777216
    s_cmp_eq_u32 s19, 1
    s_cbranch_scc1 L_qa_v_34
    s_lshl_b32 s38, s25, 7
    s_add_u32 s38, s38, 3211264
    v_lshlrev_b32 v4, 4, v3
    buffer_load_dwordx4 v[96:99], v4, s[8:11], s38 offen offset:0 sc1
    buffer_load_dwordx4 v[100:103], v4, s[8:11], s38 offen offset:32 sc1
    v_and_b32 v118, 0x330, v1
    v_bfe_u32 v5, v1, 6, 1
    v_lshl_or_b32 v118, v5, 7, v118
    v_bfe_u32 v5, v1, 7, 1
    v_lshl_or_b32 v118, v5, 6, v118
    v_lshlrev_b32 v7, 2, v2
    v_add_u32 v7, 155648, v7
    s_waitcnt vmcnt(0)
    s_barrier
    ds_read_b128 v[80:83], v113 offset:0
    ds_read_b128 v[48:51], v112 offset:0
    ds_read_b128 v[84:87], v113 offset:1024
    ds_read_b128 v[52:55], v112 offset:1024
    ds_read_b128 v[88:91], v113 offset:2048
    ds_read_b128 v[56:59], v112 offset:2048
    ds_read_b128 v[92:95], v113 offset:3072
    ds_read_b128 v[60:63], v112 offset:3072
    s_waitcnt lgkmcnt(6)
    v_mfma_f32_32x32x16_bf16 v[16:31], v[80:83], v[48:51], 0
    ds_read_b128 v[80:83], v113 offset:4096
    ds_read_b128 v[48:51], v112 offset:4096
    s_waitcnt lgkmcnt(6)
    v_mfma_f32_32x32x16_bf16 v[16:31], v[84:87], v[52:55], v[16:31]
    ds_read_b128 v[84:87], v113 offset:5120
    ds_read_b128 v[52:55], v112 offset:5120
    s_waitcnt lgkmcnt(6)
    v_mfma_f32_32x32x16_bf16 v[16:31], v[88:91], v[56:59], v[16:31]
    ds_read_b128 v[88:91], v113 offset:6144
    ds_read_b128 v[56:59], v112 offset:6144
    s_waitcnt lgkmcnt(6)
    v_mfma_f32_32x32x16_bf16 v[16:31], v[92:95], v[60:63], v[16:31]
    ds_read_b128 v[92:95], v113 offset:7168
    ds_read_b128 v[60:63], v112 offset:7168
    s_waitcnt lgkmcnt(6)
    v_mfma_f32_32x32x16_bf16 v[16:31], v[80:83], v[48:51], v[16:31]
    s_waitcnt lgkmcnt(4)
    v_mfma_f32_32x32x16_bf16 v[16:31], v[84:87], v[52:55], v[16:31]
    s_waitcnt lgkmcnt(2)
    v_mfma_f32_32x32x16_bf16 v[16:31], v[88:91], v[56:59], v[16:31]
    s_waitcnt lgkmcnt(0)
    v_mfma_f32_32x32x16_bf16 v[16:31], v[92:95], v[60:63], v[16:31]
    s_cmp_eq_u32 s3, 0
    s_cbranch_scc1 L_qa_w0_39
    s_nop 9
    ds_write_b128 v119, v[16:19] offset:0
    ds_write_b128 v119, v[20:23] offset:1024
    s_waitcnt lgkmcnt(0)
    s_barrier
    s_barrier
    s_branch L_qa_end_29
L_qa_w0_39:
    s_nop 2
    s_barrier
    ds_read2_b32 v[114:115], v7 offset0:0 offset1:32
    ds_read_b128 v[48:51], v119 offset:4608
    ds_read_b128 v[52:55], v119 offset:5632
    ds_read_b128 v[56:59], v119 offset:9216
    ds_read_b128 v[60:63], v119 offset:10240
    ds_read_b128 v[80:83], v119 offset:13824
    ds_read_b128 v[84:87], v119 offset:14848
    s_waitcnt lgkmcnt(4)
    v_pk_add_f32 v[16:17], v[16:17], v[48:49]
    v_pk_add_f32 v[18:19], v[18:19], v[50:51]
    v_pk_add_f32 v[20:21], v[20:21], v[52:53]
    v_pk_add_f32 v[22:23], v[22:23], v[54:55]
    s_waitcnt lgkmcnt(2)
    v_pk_add_f32 v[16:17], v[16:17], v[56:57]
    v_pk_add_f32 v[18:19], v[18:19], v[58:59]
    v_pk_add_f32 v[20:21], v[20:21], v[60:61]
    v_pk_add_f32 v[22:23], v[22:23], v[62:63]
    s_waitcnt lgkmcnt(0)
    v_pk_add_f32 v[16:17], v[16:17], v[80:81]
    v_pk_add_f32 v[18:19], v[18:19], v[82:83]
    v_pk_add_f32 v[20:21], v[20:21], v[84:85]
    v_pk_add_f32 v[22:23], v[22:23], v[86:87]
    v_fma_f32 v16, -v114, v96, v16
    v_fma_f32 v17, -v114, v97, v17
    v_fma_f32 v18, -v114, v98, v18
    v_fma_f32 v19, -v114, v99, v19
    v_fma_f32 v20, -v114, v100, v20
    v_fma_f32 v21, -v114, v101, v21
    v_fma_f32 v22, -v114, v102, v22
    v_fma_f32 v23, -v114, v103, v23
    v_mul_f32 v16, v115, v16
    v_mul_f32 v17, v115, v17
    v_mul_f32 v18, v115, v18
    v_mul_f32 v19, v115, v19
    v_mul_f32 v20, v115, v20
    v_mul_f32 v21, v115, v21
    v_mul_f32 v22, v115, v22
    v_mul_f32 v23, v115, v23
    v_cvt_pk_bf16_f32 v16, v16, v17
    v_cvt_pk_bf16_f32 v17, v18, v19
    v_cvt_pk_bf16_f32 v18, v20, v21
    v_cvt_pk_bf16_f32 v19, v22, v23
    buffer_store_dwordx4 v[16:19], v118, s[8:11], s27 offen sc0 sc1
    s_branch L_qa_sig_35
L_qa_v_34:
    s_lshl_b32 s38, s25, 7
    s_add_u32 s38, s38, 3211264
    v_lshlrev_b32 v4, 2, v2
    buffer_load_dword v114, v4, s[8:11], s38 offen sc1
    v_lshlrev_b32 v7, 4, v3
    v_add_u32 v7, 155648, v7
    v_and_b32 v118, 15, v2
    v_lshl_add_u32 v118, v3, 4, v118
    v_lshlrev_b32 v118, 4, v118
    s_waitcnt vmcnt(0)
    s_barrier
    ds_read_b128 v[80:83], v113 offset:0
    ds_read_b128 v[48:51], v112 offset:0
    ds_read_b128 v[84:87], v113 offset:1024
    ds_read_b128 v[52:55], v112 offset:1024
    ds_read_b128 v[88:91], v113 offset:2048
    ds_read_b128 v[56:59], v112 offset:2048
    ds_read_b128 v[92:95], v113 offset:3072
    ds_read_b128 v[60:63], v112 offset:3072
    s_waitcnt lgkmcnt(6)
    v_mfma_f32_32x32x16_bf16 v[16:31], v[48:51], v[80:83], 0
    ds_read_b128 v[80:83], v113 offset:4096
    ds_read_b128 v[48:51], v112 offset:4096
    s_waitcnt lgkmcnt(6)
    v_mfma_f32_32x32x16_bf16 v[16:31], v[52:55], v[84:87], v[16:31]
    ds_read_b128 v[84:87], v113 offset:5120
    ds_read_b128 v[52:55], v112 offset:5120
    s_waitcnt lgkmcnt(6)
    v_mfma_f32_32x32x16_bf16 v[16:31], v[56:59], v[88:91], v[16:31]
    ds_read_b128 v[88:91], v113 offset:6144
    ds_read_b128 v[56:59], v112 offset:6144
    s_waitcnt lgkmcnt(6)
    v_mfma_f32_32x32x16_bf16 v[16:31], v[60:63], v[92:95], v[16:31]
    ds_read_b128 v[92:95], v113 offset:7168
    ds_read_b128 v[60:63], v112 offset:7168
    s_waitcnt lgkmcnt(6)
    v_mfma_f32_32x32x16_bf16 v[16:31], v[48:51], v[80:83], v[16:31]
    s_waitcnt lgkmcnt(4)
    v_mfma_f32_32x32x16_bf16 v[16:31], v[52:55], v[84:87], v[16:31]
    s_waitcnt lgkmcnt(2)
    v_mfma_f32_32x32x16_bf16 v[16:31], v[56:59], v[88:91], v[16:31]
    s_waitcnt lgkmcnt(0)
    v_mfma_f32_32x32x16_bf16 v[16:31], v[60:63], v[92:95], v[16:31]
    s_cmp_eq_u32 s3, 0
    s_cbranch_scc1 L_qa_w0_40
    s_nop 9
    ds_write_b128 v119, v[16:19] offset:0
    ds_write_b128 v119, v[20:23] offset:1024
    ds_write_b128 v119, v[24:27] offset:2048
    ds_write_b128 v119, v[28:31] offset:3072
    s_waitcnt lgkmcnt(0)
    s_barrier
    s_barrier
    s_branch L_qa_end_29
L_qa_w0_40:
    s_nop 2
    s_barrier
    ds_read_b128 v[32:35], v7 offset:0
    ds_read_b128 v[64:67], v7 offset:128
    ds_read_b128 v[36:39], v7 offset:32
    ds_read_b128 v[68:71], v7 offset:160
    ds_read_b128 v[40:43], v7 offset:64
    ds_read_b128 v[72:75], v7 offset:192
    ds_read_b128 v[44:47], v7 offset:96
    ds_read_b128 v[76:79], v7 offset:224
    ds_read_b128 v[48:51], v119 offset:4608
    ds_read_b128 v[52:55], v119 offset:5632
    ds_read_b128 v[56:59], v119 offset:6656
    ds_read_b128 v[60:63], v119 offset:7680
    ds_read_b128 v[80:83], v119 offset:9216
    ds_read_b128 v[84:87], v119 offset:10240
    ds_read_b128 v[88:91], v119 offset:11264
    ds_read_b128 v[92:95], v119 offset:12288
    ds_read_b128 v[96:99], v119 offset:13824
    ds_read_b128 v[100:103], v119 offset:14848
    ds_read_b128 v[104:107], v119 offset:15872
    ds_read_b128 v[108:111], v119 offset:16896
    s_waitcnt lgkmcnt(8)
    v_pk_add_f32 v[16:17], v[16:17], v[48:49]
    v_pk_add_f32 v[18:19], v[18:19], v[50:51]
    v_pk_add_f32 v[20:21], v[20:21], v[52:53]
    v_pk_add_f32 v[22:23], v[22:23], v[54:55]
    v_pk_add_f32 v[24:25], v[24:25], v[56:57]
    v_pk_add_f32 v[26:27], v[26:27], v[58:59]
    v_pk_add_f32 v[28:29], v[28:29], v[60:61]
    v_pk_add_f32 v[30:31], v[30:31], v[62:63]
    s_waitcnt lgkmcnt(4)
    v_pk_add_f32 v[16:17], v[16:17], v[80:81]
    v_pk_add_f32 v[18:19], v[18:19], v[82:83]
    v_pk_add_f32 v[20:21], v[20:21], v[84:85]
    v_pk_add_f32 v[22:23], v[22:23], v[86:87]
    v_pk_add_f32 v[24:25], v[24:25], v[88:89]
    v_pk_add_f32 v[26:27], v[26:27], v[90:91]
    v_pk_add_f32 v[28:29], v[28:29], v[92:93]
    v_pk_add_f32 v[30:31], v[30:31], v[94:95]
    s_waitcnt lgkmcnt(0)
    v_pk_add_f32 v[16:17], v[16:17], v[96:97]
    v_pk_add_f32 v[18:19], v[18:19], v[98:99]
    v_pk_add_f32 v[20:21], v[20:21], v[100:101]
    v_pk_add_f32 v[22:23], v[22:23], v[102:103]
    v_pk_add_f32 v[24:25], v[24:25], v[104:105]
    v_pk_add_f32 v[26:27], v[26:27], v[106:107]
    v_pk_add_f32 v[28:29], v[28:29], v[108:109]
    v_pk_add_f32 v[30:31], v[30:31], v[110:111]
    v_fma_f32 v16, -v32, v114, v16
    v_fma_f32 v17, -v33, v114, v17
    v_fma_f32 v18, -v34, v114, v18
    v_fma_f32 v19, -v35, v114, v19
    v_fma_f32 v20, -v36, v114, v20
    v_fma_f32 v21, -v37, v114, v21
    v_fma_f32 v22, -v38, v114, v22
    v_fma_f32 v23, -v39, v114, v23
    v_fma_f32 v24, -v40, v114, v24
    v_fma_f32 v25, -v41, v114, v25
    v_fma_f32 v26, -v42, v114, v26
    v_fma_f32 v27, -v43, v114, v27
    v_fma_f32 v28, -v44, v114, v28
    v_fma_f32 v29, -v45, v114, v29
    v_fma_f32 v30, -v46, v114, v30
    v_fma_f32 v31, -v47, v114, v31
    v_mul_f32 v16, v64, v16
    v_mul_f32 v17, v65, v17
    v_mul_f32 v18, v66, v18
    v_mul_f32 v19, v67, v19
    v_mul_f32 v20, v68, v20
    v_mul_f32 v21, v69, v21
    v_mul_f32 v22, v70, v22
    v_mul_f32 v23, v71, v23
    v_mul_f32 v24, v72, v24
    v_mul_f32 v25, v73, v25
    v_mul_f32 v26, v74, v26
    v_mul_f32 v27, v75, v27
    v_mul_f32 v28, v76, v28
    v_mul_f32 v29, v77, v29
    v_mul_f32 v30, v78, v30
    v_mul_f32 v31, v79, v31
    v_cvt_pk_bf16_f32 v16, v16, v17
    v_cvt_pk_bf16_f32 v17, v18, v19
    v_cvt_pk_bf16_f32 v18, v20, v21
    v_cvt_pk_bf16_f32 v19, v22, v23
    v_cvt_pk_bf16_f32 v20, v24, v25
    v_cvt_pk_bf16_f32 v21, v26, v27
    v_cvt_pk_bf16_f32 v22, v28, v29
    v_cvt_pk_bf16_f32 v23, v30, v31
    s_mov_b32 exec_lo, 0xffff0000
    s_mov_b32 exec_hi, 0xffff0000
    buffer_store_dwordx4 v[16:19], v118, s[8:11], s27 offen offset:1024 sc0 sc1
    buffer_store_dwordx4 v[20:23], v118, s[8:11], s27 offen offset:1536 sc0 sc1
    s_mov_b64 exec, -1
L_qa_sig_35:
    s_barrier
L_arrive:
    s_lshr_b32 s37, s18, 3
    s_mul_i32 s37, s37, 4352
    s_and_b32 s23, s18, 7
    s_lshl_b32 s23, s23, 2
    s_add_u32 s23, s23, s19
    s_lshl_b32 s23, s23, 3
    s_add_u32 s37, s37, s23
    s_add_u32 s37, s37, 42082304
    v_mov_b32 v4, s62
    v_mov_b32 v5, s63
    v_mov_b32 v6, 0
    s_mov_b64 exec, 1
    s_waitcnt vmcnt(0)
    buffer_store_dwordx2 v[4:5], v6, s[8:11], s37 offen sc0 sc1
    s_mov_b64 exec, -1
    s_branch L_qa_end_29
L_qa_idle_36:
    s_waitcnt vmcnt(0)
    s_barrier
    s_barrier
    s_barrier
L_qa_end_29:
L_qa_end:
    s_waitcnt lgkmcnt(0)
    v_mov_b32 v112, 0xdddddddd
    s_mov_b32 s30, 0x110000
    s_mov_b32 s31, 0x110000
    v_mov_b32 v32, 0x3f803f80
    v_cndmask_b32 v32, 0, v32, s[30:31]
    v_mov_b32 v33, v32
    v_mov_b32 v34, v32
    v_mov_b32 v35, v32
    v_mov_b32 v36, v32
    v_mov_b32 v37, v32
    v_mov_b32 v38, v32
    v_mov_b32 v39, v32
    v_mov_b32 v40, v32
    v_mov_b32 v41, v32
    v_mov_b32 v42, v32
    v_mov_b32 v43, v32
    v_mov_b32 v44, v32
    v_mov_b32 v45, v32
    v_mov_b32 v46, v32
    v_mov_b32 v47, v32
    s_mov_b32 s30, 0xffff
    s_mov_b32 s31, 0xffff
    v_mov_b32 v80, 0
    v_mov_b32 v81, 0
    v_mov_b32 v82, 0
    v_mov_b32 v83, 0
    v_mov_b32 v84, 0
    v_mov_b32 v85, 0
    v_mov_b32 v86, 0
    v_mov_b32 v87, 0
    v_mov_b32 v88, 0
    v_mov_b32 v89, 0
    v_mov_b32 v90, 0
    v_mov_b32 v91, 0
    v_mov_b32 v92, 0
    v_mov_b32 v93, 0
    v_mov_b32 v94, 0
    v_mov_b32 v95, 0
    v_mov_b32 v96, 0
    v_mov_b32 v97, 0
    v_mov_b32 v98, 0
    v_mov_b32 v99, 0
    v_mov_b32 v100, 0
    v_mov_b32 v101, 0
    v_mov_b32 v102, 0
    v_mov_b32 v103, 0
    v_mov_b32 v104, 0
    v_mov_b32 v105, 0
    v_mov_b32 v106, 0
    v_mov_b32 v107, 0
    v_mov_b32 v108, 0
    v_mov_b32 v109, 0
    v_mov_b32 v110, 0
    v_mov_b32 v111, 0
    v_mov_b32 v72, 0
    v_mov_b32 v73, 0
    v_mov_b32 v74, 0
    v_mov_b32 v75, 0
    v_mov_b32 v76, 0
    v_mov_b32 v77, 0
    v_mov_b32 v78, 0
    v_mov_b32 v79, 0
    s_lshr_b32 s25, s3, 2
    s_lshl_b32 s22, s25, 11
    v_add_u32 v113, s22, v1
    v_and_b32 v114, 15, v2
    v_lshl_add_u32 v114, v3, 4, v114
    v_lshlrev_b32 v114, 4, v114
    s_add_u32 s22, s22, 1024
    v_add_u32 v114, s22, v114
    s_lshl_b32 s28, s47, 11
    s_lshl_b32 s22, s18, 15
    s_add_u32 s28, s28, s22
    s_lshl_b32 s29, s16, 16
    s_and_b32 s22, s46, 1
    s_lshl_b32 s22, s22, 15
    s_add_u32 s29, s29, s22
    s_lshl_b32 s22, s17, 12
    s_add_u32 s29, s29, s22
    s_and_b32 s22, s46, 2
    s_lshl_b32 s22, s22, 10
    s_add_u32 s29, s29, s22
    s_cmp_eq_u32 s20, 0
    s_cselect_b32 s28, s29, s28
    s_add_u32 s28, s28, 8388608
    s_add_u32 s29, s28, 1024
    s_mul_i32 s22, s46, 4608
    s_add_u32 s22, s22, 139264
    v_add_u32 v116, s22, v1
    v_lshrrev_b32 v117, 2, v1
    v_add_u32 v117, s22, v117
    s_lshl_b32 s22, s46, 2
    v_add_u32 v118, s22, v123
    s_lshl_b32 s22, s25, 2
    v_add_u32 v120, s22, v123
    s_lshl_b32 s26, s59, 2
    s_lshl_b32 s27, s59, 3
    s_lshl_b32 s22, s46, 11
    s_add_u32 s22, s22, 147456
    v_add_u32 v6, s22, v1
    s_lshl_b32 s43, s46, 12
    s_lshl_b32 s42, s25, 11
    s_add_u32 s43, s43, s42
    s_add_u32 s43, s43, 32768
    s_add_u32 s42, s43, 16777216
    s_add_u32 s42, s42, s21
    s_getpc_b64 s[32:33]
L_aa_pc_44:
    s_add_u32 s32, s32, L_aa_body-L_aa_pc_44
    s_addc_u32 s33, s33, 0
    s_cmp_ge_u32 s3, 4
    s_cbranch_scc1 L_aa_H_41
    s_add_u32 s24, s47, 17
    s_lshl_b32 s48, s24, 15
    s_add_u32 s49, s48, 4096
    s_add_u32 s50, s48, 8192
    s_add_u32 s51, s48, 12288
    s_add_u32 s52, s48, 16384
    s_add_u32 s53, s48, 20480
    s_add_u32 s54, s48, 24576
    s_add_u32 s55, s48, 28672
    s_cmp_ge_u32 s3, 2
    s_cbranch_scc1 L_aa_pl_45
    s_and_b32 s22, s18, 7
    s_lshl_b32 s22, s22, 4
    s_lshl_b32 s23, s19, 2
    s_add_u32 s22, s22, s23
    s_add_u32 s22, s22, s3
    s_cmp_lg_u32 s22, 5
    s_cbranch_scc1 L_aa_j_42
    s_lshr_b32 s23, s18, 3
    s_mul_i32 s38, s23, 4352
    s_add_u32 s38, s38, 42082304
    s_lshl_b32 s23, s23, 3
    s_add_u32 s23, s23, 41943040
    s_mov_b32 s44, 0x33333333
    s_mov_b32 s45, 0
    v_mul_u32_u24 v119, 4352, v2
    v_lshrrev_b32 v7, 1, v1
    s_mov_b32 s40, 400000
    s_mov_b64 exec, s[44:45]
L_poll_46:
    buffer_load_dwordx2 v[4:5], v7, s[8:11], s38 offen sc1
    s_waitcnt vmcnt(0)
    v_cmp_ne_u64 vcc, s[62:63], v[4:5]
    s_cbranch_vccz L_polled_47
    s_sleep 1
    s_sub_u32 s40, s40, 1
    s_cmp_lg_u32 s40, 0
    s_cbranch_scc1 L_poll_46
L_polled_47:
    s_mov_b64 exec, -1
    v_mov_b32 v4, s62
    v_mov_b32 v5, s63
    s_mov_b32 exec_hi, 0
    buffer_store_dwordx2 v[4:5], v119, s[8:11], s23 offen sc0 sc1
    s_mov_b64 exec, -1
    s_branch L_aa_j_42
L_aa_pl_45:
    s_and_b32 s23, s3, 1
    s_lshl_b32 s23, s23, 14
    s_add_u32 s22, s23, 16777216
    s_add_u32 s22, s22, s21
    s_mul_i32 s38, s16, 4352
    s_add_u32 s38, s38, 41943040
    s_mov_b32 s41, s22
L_cw_48:
    ds_read_b32 v4, v123 offset:56
    s_waitcnt lgkmcnt(0)
    v_readfirstlane_b32 s22, v4
    s_nop 0
    s_cmp_lt_u32 s22, 4
    s_cbranch_scc1 L_cw_48
    s_mov_b32 s22, s41
    v_lshrrev_b32 v7, 1, v1
    s_mov_b32 s40, 400000
    s_mov_b64 exec, 0xff
L_poll_49:
    buffer_load_dwordx2 v[4:5], v7, s[8:11], s38 offen sc1
    s_waitcnt vmcnt(0)
    v_cmp_ne_u64 vcc, s[62:63], v[4:5]
    s_cbranch_vccz L_polled_50
    s_sleep 1
    s_sub_u32 s40, s40, 1
    s_cmp_lg_u32 s40, 0
    s_cbranch_scc1 L_poll_49
L_polled_50:
    s_mov_b64 exec, -1
    s_mov_b32 m0, s23
    s_nop 0
    buffer_load_dwordx4 v1, s[8:11], s22 offen offset:0 sc1 lds
    buffer_load_dwordx4 v1, s[8:11], s22 offen offset:1024 sc1 lds
    buffer_load_dwordx4 v1, s[8:11], s22 offen offset:2048 sc1 lds
    buffer_load_dwordx4 v1, s[8:11], s22 offen offset:3072 sc1 lds
    s_add_u32 s22, s22, 4096
    s_add_u32 s23, s23, 4096
    s_mov_b32 m0, s23
    s_nop 0
    buffer_load_dwordx4 v1, s[8:11], s22 offen offset:0 sc1 lds
    buffer_load_dwordx4 v1, s[8:11], s22 offen offset:1024 sc1 lds
    buffer_load_dwordx4 v1, s[8:11], s22 offen offset:2048 sc1 lds
    buffer_load_dwordx4 v1, s[8:11], s22 offen offset:3072 sc1 lds
    s_add_u32 s22, s22, 4096
    s_add_u32 s23, s23, 4096
    s_mov_b32 m0, s23
    s_nop 0
    buffer_load_dwordx4 v1, s[8:11], s22 offen offset:0 sc1 lds
    buffer_load_dwordx4 v1, s[8:11], s22 offen offset:1024 sc1 lds
    buffer_load_dwordx4 v1, s[8:11], s22 offen offset:2048 sc1 lds
    buffer_load_dwordx4 v1, s[8:11], s22 offen offset:3072 sc1 lds
    s_add_u32 s22, s22, 4096
    s_add_u32 s23, s23, 4096
    s_mov_b32 m0, s23
    s_nop 0
    buffer_load_dwordx4 v1, s[8:11], s22 offen offset:0 sc1 lds
    buffer_load_dwordx4 v1, s[8:11], s22 offen offset:1024 sc1 lds
    buffer_load_dwordx4 v1, s[8:11], s22 offen offset:2048 sc1 lds
    buffer_load_dwordx4 v1, s[8:11], s22 offen offset:3072 sc1 lds
    s_branch L_aa_j_42
L_aa_H_41:
    s_lshr_b32 s24, s46, 1
    s_lshl_b32 s24, s24, 4
    s_and_b32 s23, s46, 1
    s_add_u32 s24, s24, s23
    s_lshl_b32 s23, s17, 1
    s_add_u32 s24, s24, s23
    s_add_u32 s24, s24, 49
    s_lshl_b32 s48, s24, 15
    s_add_u32 s49, s48, 4096
    s_add_u32 s50, s48, 8192
    s_add_u32 s51, s48, 12288
    s_add_u32 s52, s48, 16384
    s_add_u32 s53, s48, 20480
    s_add_u32 s54, s48, 24576
    s_add_u32 s55, s48, 28672
L_aa_j_42:
    s_waitcnt vmcnt(0) lgkmcnt(0)
    s_barrier
    ds_read_b128 v[16:19], v6
    ds_read_b128 v[24:27], v113
    ds_read_b128 v[20:23], v6 offset:1024
    ds_read_b128 v[28:31], v113 offset:4096
    s_mov_b64 exec, s[30:31]
    ds_read_b128 v[32:35], v114
    ds_read_b128 v[36:39], v114 offset:512
    s_mov_b64 exec, -1
    s_waitcnt lgkmcnt(4)
    v_mfma_f32_32x32x16_bf16 v[48:63], v[24:27], v[16:19], 0
    s_cmp_eq_u32 s20, 0
    s_cbranch_scc1 L_aa_arr
L_aa_arr_ret:
    s_mov_b32 m0, s43
    s_add_u32 s43, s43, 16384
    buffer_load_dwordx4 v1, s[8:11], s42 offen offset:0 sc1 lds
    buffer_load_dwordx4 v1, s[8:11], s42 offen offset:1024 sc1 lds
    s_add_u32 s42, s42, 16384
    s_mov_b32 m0, s43
    s_add_u32 s43, s43, 16384
    buffer_load_dwordx4 v1, s[8:11], s42 offen offset:0 sc1 lds
    buffer_load_dwordx4 v1, s[8:11], s42 offen offset:1024 sc1 lds
    s_add_u32 s42, s42, 16384
    s_mov_b32 m0, s43
    s_add_u32 s43, s43, 16384
    buffer_load_dwordx4 v1, s[8:11], s42 offen offset:0 sc1 lds
    buffer_load_dwordx4 v1, s[8:11], s42 offen offset:1024 sc1 lds
    s_add_u32 s42, s42, 16384
    s_setprio 3
    s_swappc_b64 s[34:35], s[32:33]
    s_waitcnt vmcnt(0)
    s_mov_b64 exec, 1
    ds_add_u32 v120, v122 offset:0
    s_mov_b64 exec, -1
    s_mov_b32 m0, s43
    s_add_u32 s43, s43, 16384
    buffer_load_dwordx4 v1, s[8:11], s42 offen offset:0 sc1 lds
    buffer_load_dwordx4 v1, s[8:11], s42 offen offset:1024 sc1 lds
    s_add_u32 s42, s42, 16384
    s_mov_b32 m0, s43
    s_add_u32 s43, s43, 16384
    buffer_load_dwordx4 v1, s[8:11], s42 offen offset:0 sc1 lds
    buffer_load_dwordx4 v1, s[8:11], s42 offen offset:1024 sc1 lds
    s_add_u32 s42, s42, 16384
    s_mov_b32 m0, s43
    s_add_u32 s43, s43, 16384
    buffer_load_dwordx4 v1, s[8:11], s42 offen offset:0 sc1 lds
    buffer_load_dwordx4 v1, s[8:11], s42 offen offset:1024 sc1 lds
    s_add_u32 s42, s42, 16384
L_cw_51:
    ds_read_b32 v119, v120 offset:0
    s_waitcnt lgkmcnt(0)
    v_readfirstlane_b32 s22, v119
    s_nop 0
    s_cmp_lt_u32 s22, s26
    s_cbranch_scc1 L_cw_51
    s_swappc_b64 s[34:35], s[32:33]
    s_waitcnt vmcnt(0)
    s_mov_b64 exec, 1
    ds_add_u32 v120, v122 offset:8
    s_mov_b64 exec, -1
    s_cmp_eq_u32 s20, 0
    s_cbranch_scc1 L_aa_lead
L_aa_lead_ret:
    s_swappc_b64 s[34:35], s[32:33]
    s_swappc_b64 s[34:35], s[32:33]
    s_cmp_eq_u32 s20, 0
    s_cbranch_scc1 L_aa_warm
L_aa_warm_ret:
    s_mov_b64 exec, 1
    ds_add_u32 v123, v122 offset:16
    s_mov_b64 exec, -1
L_cw_53:
    ds_read_b32 v119, v120 offset:8
    s_waitcnt lgkmcnt(0)
    v_readfirstlane_b32 s22, v119
    s_nop 0
    s_cmp_lt_u32 s22, s26
    s_cbranch_scc1 L_cw_53
    s_setprio 2
    s_swappc_b64 s[34:35], s[32:33]
    s_cmp_eq_u32 s20, 0
    s_cbranch_scc1 L_aa_wrdy
L_aa_wrdy_ret:
    buffer_load_dwordx4 v[128:131], v1, s[8:11], s48 offen offset:0 sc1
    buffer_load_dwordx4 v[132:135], v1, s[8:11], s48 offen offset:1024 sc1
    buffer_load_dwordx4 v[136:139], v1, s[8:11], s48 offen offset:2048 sc1
    buffer_load_dwordx4 v[140:143], v1, s[8:11], s48 offen offset:3072 sc1
    buffer_load_dwordx4 v[144:147], v1, s[8:11], s49 offen offset:0 sc1
    buffer_load_dwordx4 v[148:151], v1, s[8:11], s49 offen offset:1024 sc1
    buffer_load_dwordx4 v[152:155], v1, s[8:11], s49 offen offset:2048 sc1
    buffer_load_dwordx4 v[156:159], v1, s[8:11], s49 offen offset:3072 sc1
    buffer_load_dwordx4 v[160:163], v1, s[8:11], s50 offen offset:0 sc1
    buffer_load_dwordx4 v[164:167], v1, s[8:11], s50 offen offset:1024 sc1
    buffer_load_dwordx4 v[168:171], v1, s[8:11], s50 offen offset:2048 sc1
    buffer_load_dwordx4 v[172:175], v1, s[8:11], s50 offen offset:3072 sc1
    buffer_load_dwordx4 v[176:179], v1, s[8:11], s51 offen offset:0 sc1
    buffer_load_dwordx4 v[180:183], v1, s[8:11], s51 offen offset:1024 sc1
    s_swappc_b64 s[34:35], s[32:33]
L_cw_55:
    ds_read_b32 v119, v123 offset:16
    s_waitcnt lgkmcnt(0)
    v_readfirstlane_b32 s22, v119
    s_nop 0
    s_cmp_lt_u32 s22, s27
    s_cbranch_scc1 L_cw_55
    s_lshl_b32 s42, s17, 16
    s_lshl_b32 s43, s3, 13
    s_add_u32 s42, s42, s43
    s_add_u32 s42, s42, 1081344
    s_add_u32 s43, s43, 0
    s_mov_b32 m0, s43
    s_nop 0
    buffer_load_dwordx4 v1, s[8:11], s42 offen offset:0 sc1 lds
    buffer_load_dwordx4 v1, s[8:11], s42 offen offset:1024 sc1 lds
    buffer_load_dwordx4 v1, s[8:11], s42 offen offset:2048 sc1 lds
    buffer_load_dwordx4 v1, s[8:11], s42 offen offset:3072 sc1 lds
    s_add_u32 s42, s42, 4096
    s_add_u32 s43, s43, 4096
    s_mov_b32 m0, s43
    s_nop 0
    buffer_load_dwordx4 v1, s[8:11], s42 offen offset:0 sc1 lds
    buffer_load_dwordx4 v1, s[8:11], s42 offen offset:1024 sc1 lds
    buffer_load_dwordx4 v1, s[8:11], s42 offen offset:2048 sc1 lds
    buffer_load_dwordx4 v1, s[8:11], s42 offen offset:3072 sc1 lds
    buffer_load_dwordx4 v[184:187], v1, s[8:11], s51 offen offset:2048 sc1
    buffer_load_dwordx4 v[188:191], v1, s[8:11], s51 offen offset:3072 sc1
    buffer_load_dwordx4 v[192:195], v1, s[8:11], s52 offen offset:0 sc1
    buffer_load_dwordx4 v[196:199], v1, s[8:11], s52 offen offset:1024 sc1
    buffer_load_dwordx4 v[200:203], v1, s[8:11], s52 offen offset:2048 sc1
    buffer_load_dwordx4 v[204:207], v1, s[8:11], s52 offen offset:3072 sc1
    buffer_load_dwordx4 v[208:211], v1, s[8:11], s53 offen offset:0 sc1
    buffer_load_dwordx4 v[212:215], v1, s[8:11], s53 offen offset:1024 sc1
    s_setprio 1
    s_swappc_b64 s[34:35], s[32:33]
    s_cmp_lg_u32 s20, 0
    s_cbranch_scc1 L_aa_cpf_57
    s_getpc_b64 s[40:41]
L_aa_cpc_58:
    s_sub_u32 s40, s40, L_aa_cpc_58-L_iter
    s_subb_u32 s41, s41, 0
    v_lshlrev_b32 v119, 6, v0
    v_min_u32 v119, L_text_end-L_iter-4, v119
    global_load_dword v124, v119, s[40:41] sc1
L_aa_cpf_57:
    buffer_load_dwordx4 v[216:219], v1, s[8:11], s53 offen offset:2048 sc1
    buffer_load_dwordx4 v[220:223], v1, s[8:11], s53 offen offset:3072 sc1
    buffer_load_dwordx4 v[224:227], v1, s[8:11], s54 offen offset:0 sc1
    buffer_load_dwordx4 v[228:231], v1, s[8:11], s54 offen offset:1024 sc1
    buffer_load_dwordx4 v[232:235], v1, s[8:11], s54 offen offset:2048 sc1
    buffer_load_dwordx4 v[236:239], v1, s[8:11], s54 offen offset:3072 sc1
    buffer_load_dwordx4 v[240:243], v1, s[8:11], s55 offen offset:0 sc1
    buffer_load_dwordx4 v[244:247], v1, s[8:11], s55 offen offset:1024 sc1
    buffer_load_dwordx4 v[248:251], v1, s[8:11], s55 offen offset:2048 sc1
    buffer_load_dwordx4 v[252:255], v1, s[8:11], s55 offen offset:3072 sc1
    s_setprio 0
    s_swappc_b64 s[34:35], s[32:33]
    v_smfmac_f32_32x32x32_bf16 v[96:111], v[44:47], v[72:79], v112
    s_cmp_ge_u32 s3, 4
    s_cbranch_scc1 L_fin_H_59
    s_nop 9
    ds_write_b128 v116, v[80:83] offset:0
    ds_write_b128 v116, v[84:87] offset:1024
    ds_write_b32 v117, v88 offset:2048
    ds_write_b128 v116, v[96:99] offset:2304
    ds_write_b128 v116, v[100:103] offset:3328
    ds_write_b32 v117, v104 offset:4352
    s_waitcnt lgkmcnt(0)
    s_mov_b64 exec, 1
    ds_add_u32 v118, v122 offset:32
    s_mov_b64 exec, -1
    s_branch L_aa_end_43
L_fin_H_59:
    s_lshl_b32 s23, s20, 1
    s_add_u32 s23, s23, 1
L_fin_w_60:
    ds_read_b32 v119, v118 offset:32
    ds_read_b128 v[24:27], v116 offset:0
    ds_read_b128 v[28:31], v116 offset:1024
    ds_read_b32 v6, v117 offset:2048
    ds_read_b128 v[32:35], v116 offset:2304
    ds_read_b128 v[36:39], v116 offset:3328
    ds_read_b32 v7, v117 offset:4352
    s_waitcnt lgkmcnt(6)
    v_readfirstlane_b32 s22, v119
    s_lshl_b32 s37, s20, 2
    s_add_u32 s37, s37, 1
    v_mov_b32 v5, s37
    v_lshlrev_b32 v4, 9, v2
    s_lshl_b32 s37, s16, 12
    s_lshl_b32 s44, s17, 5
    s_add_u32 s37, s37, s44
    s_lshl_b32 s44, s3, 2
    s_add_u32 s37, s37, s44
    s_add_u32 s37, s37, 42991616
    s_mov_b64 s[44:45], 0xff
    s_waitcnt lgkmcnt(0)
    s_cmp_lt_u32 s22, s23
    s_cbranch_scc1 L_fin_w_60
    v_add_f32 v88, v88, v6
    v_add_f32 v104, v104, v7
    v_pk_add_f32 v[80:81], v[80:81], v[24:25]
    v_pk_add_f32 v[82:83], v[82:83], v[26:27]
    v_pk_add_f32 v[84:85], v[84:85], v[28:29]
    v_pk_add_f32 v[86:87], v[86:87], v[30:31]
    v_pk_add_f32 v[96:97], v[96:97], v[32:33]
    v_pk_add_f32 v[98:99], v[98:99], v[34:35]
    v_pk_add_f32 v[100:101], v[100:101], v[36:37]
    v_pk_add_f32 v[102:103], v[102:103], v[38:39]
    v_cmp_nle_f32 vcc, 0x2b800000, v88
    s_mov_b64 s[40:41], vcc
    v_cmp_nge_f32 vcc, 0x53800000, v88
    s_or_b64 s[40:41], s[40:41], vcc
    v_cmp_nle_f32 vcc, 0x2b800000, v104
    s_or_b64 s[40:41], s[40:41], vcc
    v_cmp_nge_f32 vcc, 0x53800000, v104
    s_or_b64 s[40:41], s[40:41], vcc
    s_cbranch_scc1 L_aa_slow
L_aa_store:
    v_rcp_f32 v88, v88
    v_rcp_f32 v104, v104
    v_pk_mul_f32 v[80:81], v[80:81], v[88:89] op_sel_hi:[1,0]
    v_pk_mul_f32 v[82:83], v[82:83], v[88:89] op_sel_hi:[1,0]
    v_pk_mul_f32 v[84:85], v[84:85], v[88:89] op_sel_hi:[1,0]
    v_pk_mul_f32 v[86:87], v[86:87], v[88:89] op_sel_hi:[1,0]
    v_cvt_pk_bf16_f32 v80, v80, v81
    v_cvt_pk_bf16_f32 v81, v82, v83
    v_cvt_pk_bf16_f32 v82, v84, v85
    v_cvt_pk_bf16_f32 v83, v86, v87
    v_pk_mul_f32 v[96:97], v[96:97], v[104:105] op_sel_hi:[1,0]
    v_pk_mul_f32 v[98:99], v[98:99], v[104:105] op_sel_hi:[1,0]
    v_pk_mul_f32 v[100:101], v[100:101], v[104:105] op_sel_hi:[1,0]
    v_pk_mul_f32 v[102:103], v[102:103], v[104:105] op_sel_hi:[1,0]
    v_cvt_pk_bf16_f32 v96, v96, v97
    v_cvt_pk_bf16_f32 v97, v98, v99
    v_cvt_pk_bf16_f32 v98, v100, v101
    v_cvt_pk_bf16_f32 v99, v102, v103
    s_cmp_eq_u32 s56, 0
    s_cbranch_scc1 L_ts_61
    buffer_store_dwordx4 v[80:83], v1, s[8:11], s28 offen nt
    buffer_store_dwordx4 v[96:99], v1, s[8:11], s29 offen nt
    s_waitcnt vmcnt(0)
    s_mov_b64 exec, s[44:45]
    buffer_store_dword v5, v4, s[8:11], s37 offen nt
    s_mov_b64 exec, -1
L_ts_62:
L_aa_end_43:
    s_cmp_lt_u32 s3, 4
    s_cbranch_scc1 L_op_L_63
    s_waitcnt vmcnt(0)
    s_barrier
    s_branch L_op_end_64
L_op_L_63:
    s_waitcnt lgkmcnt(0)
    v_add_u32 v112, 81920, v1
    v_lshlrev_b32 v96, 16, v8
    v_and_b32 v97, 0xffff0000, v8
    v_lshlrev_b32 v98, 16, v9
    v_and_b32 v99, 0xffff0000, v9
    v_lshlrev_b32 v100, 16, v10
    v_and_b32 v101, 0xffff0000, v10
    v_lshlrev_b32 v102, 16, v11
    v_and_b32 v103, 0xffff0000, v11
    v_lshlrev_b32 v104, 16, v12
    v_and_b32 v105, 0xffff0000, v12
    v_lshlrev_b32 v106, 16, v13
    v_and_b32 v107, 0xffff0000, v13
    v_lshlrev_b32 v108, 16, v14
    v_and_b32 v109, 0xffff0000, v14
    v_lshlrev_b32 v110, 16, v15
    v_and_b32 v111, 0xffff0000, v15
    s_lshl_b32 s22, s18, 15
    s_lshl_b32 s23, s47, 11
    s_add_u32 s26, s22, s23
    s_add_u32 s26, s26, 4194304
    s_lshl_b32 s22, s18, 12
    s_lshl_b32 s23, s47, 8
    s_add_u32 s27, s22, s23
    s_add_u32 s27, s27, 3407872
    v_lshrrev_b32 v6, 2, v1
    s_lshl_b32 s37, s20, 2
    s_add_u32 s37, s37, 2
    v_mov_b32 v119, s37
    v_lshlrev_b32 v118, 9, v2
    s_lshl_b32 s37, s16, 12
    s_lshl_b32 s44, s17, 5
    s_add_u32 s37, s37, s44
    s_lshl_b32 s44, s3, 2
    s_add_u32 s37, s37, s44
    s_add_u32 s37, s37, 42991616
    s_mov_b64 s[44:45], 0xff
    s_lshl_b32 s22, s18, 15
    s_lshl_b32 s23, s46, 13
    s_add_u32 s22, s22, s23
    s_add_u32 s22, s22, 8388608
    s_add_u32 s23, s23, 81920
    s_lshl_b32 s39, s20, 2
    s_add_u32 s39, s39, 1
    s_bitcmp1_b32 s17, 0
    s_mov_b32 s42, 0xf000f0
    s_cselect_b32 s42, 0xf000f000, s42
    s_cmp_eq_u32 s20, 0
    s_cselect_b32 s42, 0xf0f0f0f0, s42
    s_mov_b32 s43, s42
    s_lshl_b32 s38, s46, 4
    s_lshl_b64 s[40:41], 0xffff, s38
    s_and_b64 s[42:43], s[42:43], s[40:41]
    s_lshl_b32 s38, s17, 3
    s_lshl_b64 s[40:41], 0xf0, s38
    s_or_b64 s[42:43], s[42:43], s[40:41]
    v_lshrrev_b32 v4, 2, v1
    s_mov_b32 s40, 400000
    s_mov_b64 exec, s[42:43]
L_poll_65:
    buffer_load_dword v5, v4, s[8:11], s57 offen offset:0 sc1
    s_waitcnt vmcnt(0)
    v_cmp_gt_u32 vcc, s39, v5
    s_cbranch_vccz L_polled_66
    s_sleep 1
    s_sub_u32 s40, s40, 1
    s_cmp_lg_u32 s40, 0
    s_cbranch_scc1 L_poll_65
L_polled_66:
    s_mov_b64 exec, -1
    s_mov_b32 m0, s23
    s_nop 0
    buffer_load_dwordx4 v1, s[8:11], s22 offen offset:0 sc1 lds
    buffer_load_dwordx4 v1, s[8:11], s22 offen offset:1024 sc1 lds
    buffer_load_dwordx4 v1, s[8:11], s22 offen offset:2048 sc1 lds
    buffer_load_dwordx4 v1, s[8:11], s22 offen offset:3072 sc1 lds
    s_add_u32 s22, s22, 4096
    s_add_u32 s23, s23, 4096
    s_mov_b32 m0, s23
    s_nop 0
    buffer_load_dwordx4 v1, s[8:11], s22 offen offset:0 sc1 lds
    buffer_load_dwordx4 v1, s[8:11], s22 offen offset:1024 sc1 lds
    buffer_load_dwordx4 v1, s[8:11], s22 offen offset:2048 sc1 lds
    buffer_load_dwordx4 v1, s[8:11], s22 offen offset:3072 sc1 lds
    s_waitcnt vmcnt(0)
    s_barrier
    ds_read_b128 v[48:51], v112 offset:0
    ds_read_b128 v[52:55], v112 offset:1024
    ds_read_b128 v[56:59], v112 offset:2048
    ds_read_b128 v[60:63], v112 offset:3072
    ds_read_b128 v[64:67], v112 offset:4096
    ds_read_b128 v[68:71], v112 offset:5120
    ds_read_b128 v[72:75], v112 offset:6144
    ds_read_b128 v[76:79], v112 offset:7168
    s_waitcnt lgkmcnt(7)
    v_mfma_f32_32x32x16_bf16 v[16:31], v[128:131], v[48:51], v[96:111]
    ds_read_b128 v[48:51], v112 offset:8192
    s_waitcnt lgkmcnt(7)
    v_mfma_f32_32x32x16_bf16 v[16:31], v[132:135], v[52:55], v[16:31]
    ds_read_b128 v[52:55], v112 offset:9216
    s_waitcnt lgkmcnt(7)
    v_mfma_f32_32x32x16_bf16 v[16:31], v[136:139], v[56:59], v[16:31]
    ds_read_b128 v[56:59], v112 offset:10240
    s_waitcnt lgkmcnt(7)
    v_mfma_f32_32x32x16_bf16 v[16:31], v[140:143], v[60:63], v[16:31]
    ds_read_b128 v[60:63], v112 offset:11264
    s_waitcnt lgkmcnt(7)
    v_mfma_f32_32x32x16_bf16 v[16:31], v[144:147], v[64:67], v[16:31]
    ds_read_b128 v[64:67], v112 offset:12288
    s_waitcnt lgkmcnt(7)
    v_mfma_f32_32x32x16_bf16 v[16:31], v[148:151], v[68:71], v[16:31]
    ds_read_b128 v[68:71], v112 offset:13312
    s_waitcnt lgkmcnt(7)
    v_mfma_f32_32x32x16_bf16 v[16:31], v[152:155], v[72:75], v[16:31]
    ds_read_b128 v[72:75], v112 offset:14336
    s_waitcnt lgkmcnt(7)
    v_mfma_f32_32x32x16_bf16 v[16:31], v[156:159], v[76:79], v[16:31]
    ds_read_b128 v[76:79], v112 offset:15360
    s_waitcnt lgkmcnt(7)
    v_mfma_f32_32x32x16_bf16 v[16:31], v[160:163], v[48:51], v[16:31]
    ds_read_b128 v[48:51], v112 offset:16384
    s_waitcnt lgkmcnt(7)
    v_mfma_f32_32x32x16_bf16 v[16:31], v[164:167], v[52:55], v[16:31]
    ds_read_b128 v[52:55], v112 offset:17408
    s_waitcnt lgkmcnt(7)
    v_mfma_f32_32x32x16_bf16 v[16:31], v[168:171], v[56:59], v[16:31]
    ds_read_b128 v[56:59], v112 offset:18432
    s_waitcnt lgkmcnt(7)
    v_mfma_f32_32x32x16_bf16 v[16:31], v[172:175], v[60:63], v[16:31]
    ds_read_b128 v[60:63], v112 offset:19456
    s_waitcnt lgkmcnt(7)
    v_mfma_f32_32x32x16_bf16 v[16:31], v[176:179], v[64:67], v[16:31]
    ds_read_b128 v[64:67], v112 offset:20480
    s_waitcnt lgkmcnt(7)
    v_mfma_f32_32x32x16_bf16 v[16:31], v[180:183], v[68:71], v[16:31]
    ds_read_b128 v[68:71], v112 offset:21504
    s_waitcnt lgkmcnt(7)
    v_mfma_f32_32x32x16_bf16 v[16:31], v[184:187], v[72:75], v[16:31]
    ds_read_b128 v[72:75], v112 offset:22528
    s_waitcnt lgkmcnt(7)
    v_mfma_f32_32x32x16_bf16 v[16:31], v[188:191], v[76:79], v[16:31]
    ds_read_b128 v[76:79], v112 offset:23552
    s_waitcnt lgkmcnt(7)
    v_mfma_f32_32x32x16_bf16 v[16:31], v[192:195], v[48:51], v[16:31]
    ds_read_b128 v[48:51], v112 offset:24576
    s_waitcnt lgkmcnt(7)
    v_mfma_f32_32x32x16_bf16 v[16:31], v[196:199], v[52:55], v[16:31]
    ds_read_b128 v[52:55], v112 offset:25600
    s_waitcnt lgkmcnt(7)
    v_mfma_f32_32x32x16_bf16 v[16:31], v[200:203], v[56:59], v[16:31]
    ds_read_b128 v[56:59], v112 offset:26624
    s_waitcnt lgkmcnt(7)
    v_mfma_f32_32x32x16_bf16 v[16:31], v[204:207], v[60:63], v[16:31]
    ds_read_b128 v[60:63], v112 offset:27648
    s_waitcnt lgkmcnt(7)
    v_mfma_f32_32x32x16_bf16 v[16:31], v[208:211], v[64:67], v[16:31]
    ds_read_b128 v[64:67], v112 offset:28672
    s_waitcnt lgkmcnt(7)
    v_mfma_f32_32x32x16_bf16 v[16:31], v[212:215], v[68:71], v[16:31]
    ds_read_b128 v[68:71], v112 offset:29696
    s_waitcnt lgkmcnt(7)
    v_mfma_f32_32x32x16_bf16 v[16:31], v[216:219], v[72:75], v[16:31]
    ds_read_b128 v[72:75], v112 offset:30720
    s_waitcnt lgkmcnt(7)
    v_mfma_f32_32x32x16_bf16 v[16:31], v[220:223], v[76:79], v[16:31]
    ds_read_b128 v[76:79], v112 offset:31744
    s_waitcnt lgkmcnt(7)
    v_mfma_f32_32x32x16_bf16 v[16:31], v[224:227], v[48:51], v[16:31]
    s_waitcnt lgkmcnt(6)
    v_mfma_f32_32x32x16_bf16 v[16:31], v[228:231], v[52:55], v[16:31]
    s_waitcnt lgkmcnt(5)
    v_mfma_f32_32x32x16_bf16 v[16:31], v[232:235], v[56:59], v[16:31]
    s_waitcnt lgkmcnt(4)
    v_mfma_f32_32x32x16_bf16 v[16:31], v[236:239], v[60:63], v[16:31]
    s_waitcnt lgkmcnt(3)
    v_mfma_f32_32x32x16_bf16 v[16:31], v[240:243], v[64:67], v[16:31]
    s_waitcnt lgkmcnt(2)
    v_mfma_f32_32x32x16_bf16 v[16:31], v[244:247], v[68:71], v[16:31]
    s_waitcnt lgkmcnt(1)
    v_mfma_f32_32x32x16_bf16 v[16:31], v[248:251], v[72:75], v[16:31]
    s_waitcnt lgkmcnt(0)
    v_mfma_f32_32x32x16_bf16 v[16:31], v[252:255], v[76:79], v[16:31]
    s_nop 11
    v_cvt_pk_bf16_f32 v8, v16, v17
    v_cvt_pk_bf16_f32 v9, v18, v19
    v_cvt_pk_bf16_f32 v10, v20, v21
    v_cvt_pk_bf16_f32 v11, v22, v23
    v_cvt_pk_bf16_f32 v12, v24, v25
    v_cvt_pk_bf16_f32 v13, v26, v27
    v_cvt_pk_bf16_f32 v14, v28, v29
    v_cvt_pk_bf16_f32 v15, v30, v31
    s_cmp_eq_u32 s56, 0
    s_cbranch_scc1 L_ts_67
    buffer_store_dwordx4 v[8:11], v1, s[8:11], s26 offen nt
    buffer_store_dwordx4 v[12:15], v1, s[8:11], s26 offen offset:1024 nt
L_ts_68:
    v_pk_mul_f32 v[50:51], v[16:17], v[16:17]
    v_pk_add_f32 v[48:49], v[16:17], v[18:19]
    v_pk_fma_f32 v[50:51], v[18:19], v[18:19], v[50:51]
    v_pk_fma_f32 v[50:51], v[20:21], v[20:21], v[50:51]
    v_pk_add_f32 v[48:49], v[48:49], v[20:21]
    v_pk_fma_f32 v[50:51], v[22:23], v[22:23], v[50:51]
    v_pk_add_f32 v[48:49], v[48:49], v[22:23]
    v_pk_fma_f32 v[50:51], v[24:25], v[24:25], v[50:51]
    v_pk_add_f32 v[48:49], v[48:49], v[24:25]
    v_pk_fma_f32 v[50:51], v[26:27], v[26:27], v[50:51]
    v_pk_add_f32 v[48:49], v[48:49], v[26:27]
    v_pk_fma_f32 v[50:51], v[28:29], v[28:29], v[50:51]
    v_pk_add_f32 v[48:49], v[48:49], v[28:29]
    v_pk_fma_f32 v[50:51], v[30:31], v[30:31], v[50:51]
    v_pk_add_f32 v[48:49], v[48:49], v[30:31]
    v_add_f32 v48, v48, v49
    v_add_f32 v50, v50, v51
    s_nop 1
    v_permlane32_swap_b32 v48, v50
    v_add_f32 v48, v48, v50
    s_cmp_eq_u32 s56, 0
    s_cbranch_scc1 L_ts_69
    buffer_store_dword v48, v6, s[8:11], s27 offen nt
    s_mov_b64 exec, s[44:45]
    s_waitcnt vmcnt(1)
    buffer_store_dword v119, v118, s[8:11], s37 offen nt
    s_waitcnt vmcnt(1)
    buffer_store_dword v119, v118, s[8:11], s37 offen offset:16 nt
    s_mov_b64 exec, -1
L_ts_70:
L_op_end_64:
    s_and_b32 s25, s46, 1
    s_lshl_b32 s23, s46, 2
    v_add_u32 v120, s23, v123
    v_add_u32 v112, 81920, v1
    s_cmp_lt_u32 s3, 4
    s_cbranch_scc1 L_qb_L_71
    s_lshl_b32 s26, s17, 19
    s_lshl_b32 s23, s16, 14
    s_add_u32 s26, s26, s23
    s_lshl_b32 s23, s25, 12
    s_add_u32 s26, s26, s23
    s_add_u32 s26, s26, s21
    s_add_u32 s26, s26, 12582912
    s_add_u32 s27, s26, 8192
    s_add_u32 s28, s23, 65536
    s_and_b32 s60, s46, 2
    s_lshl_b32 s60, s60, 9
    s_add_u32 s60, s60, s26
    s_lshr_b32 s24, s46, 1
    s_lshl_b32 s24, s24, 4
    s_and_b32 s23, s46, 1
    s_add_u32 s24, s24, s23
    s_lshl_b32 s23, s17, 1
    s_add_u32 s24, s24, s23
    s_add_u32 s24, s24, 49
    s_lshl_b32 s48, s47, 15
    s_add_u32 s49, s48, 4096
    s_add_u32 s50, s48, 8192
    s_add_u32 s51, s48, 12288
    s_add_u32 s52, s48, 16384
    s_add_u32 s53, s48, 20480
    s_add_u32 s54, s48, 24576
    s_add_u32 s55, s48, 28672
    s_cmp_ge_u32 s46, 2
    s_cbranch_scc1 L_qb_h_75
    s_lshl_b32 s38, s24, 7
    s_add_u32 s38, s38, 3211264
    v_lshlrev_b32 v4, 4, v3
    buffer_load_dwordx4 v[96:99], v4, s[8:11], s38 offen offset:0 sc1
    buffer_load_dwordx4 v[100:103], v4, s[8:11], s38 offen offset:32 sc1
    buffer_load_dwordx4 v[104:107], v4, s[8:11], s38 offen offset:64 sc1
    buffer_load_dwordx4 v[108:111], v4, s[8:11], s38 offen offset:96 sc1
    v_and_b32 v118, 0x330, v1
    v_bfe_u32 v5, v1, 6, 1
    v_lshl_or_b32 v118, v5, 7, v118
    v_bfe_u32 v5, v1, 7, 1
    v_lshl_or_b32 v118, v5, 6, v118
    v_lshlrev_b32 v7, 2, v2
    v_add_u32 v7, 155648, v7
    s_branch L_qb_h_76
L_qb_h_75:
    s_lshl_b32 s38, s24, 7
    s_add_u32 s38, s38, 3211264
    v_lshlrev_b32 v4, 2, v2
    buffer_load_dword v114, v4, s[8:11], s38 offen sc1
    v_lshlrev_b32 v7, 4, v3
    v_add_u32 v7, 155648, v7
    v_and_b32 v118, 15, v2
    v_lshl_add_u32 v118, v3, 4, v118
    v_lshlrev_b32 v118, 4, v118
    v_lshrrev_b32 v119, 4, v2
    v_lshl_add_u32 v118, v119, 11, v118
L_qb_h_76:
    v_add_u32 v119, s28, v118
    s_lshl_b32 s22, s16, 16
    s_lshl_b32 s23, s46, 13
    s_add_u32 s22, s22, s23
    s_add_u32 s22, s22, 4194304
    s_add_u32 s23, s23, 81920
    s_add_u32 s24, s22, 32768
    s_add_u32 s29, s23, 32768
    s_lshl_b32 s39, s20, 2
    s_add_u32 s39, s39, 2
    s_bitcmp1_b32 s17, 0
    s_mov_b32 s42, 0xf0f0f0f
    s_cselect_b32 s42, 0xf0f0f0f, s42
    s_mov_b32 s43, s42
    s_lshl_b32 s38, s46, 4
    s_lshl_b64 s[40:41], 0xffff, s38
    s_and_b64 s[42:43], s[42:43], s[40:41]
    s_lshl_b32 s38, s17, 3
    s_lshl_b64 s[40:41], 0xf, s38
    s_or_b64 s[42:43], s[42:43], s[40:41]
    v_lshrrev_b32 v4, 2, v1
    s_mov_b32 s40, 400000
    s_mov_b64 exec, s[42:43]
L_poll_77:
    buffer_load_dword v5, v4, s[8:11], s57 offen offset:0 sc1
    s_waitcnt vmcnt(0)
    v_cmp_gt_u32 vcc, s39, v5
    s_cbranch_vccz L_polled_78
    s_sleep 1
    s_sub_u32 s40, s40, 1
    s_cmp_lg_u32 s40, 0
    s_cbranch_scc1 L_poll_77
L_polled_78:
    s_mov_b64 exec, -1
    s_mov_b32 m0, s23
    s_nop 0
    buffer_load_dwordx4 v1, s[8:11], s22 offen offset:0 sc1 lds
    buffer_load_dwordx4 v1, s[8:11], s22 offen offset:1024 sc1 lds
    buffer_load_dwordx4 v1, s[8:11], s22 offen offset:2048 sc1 lds
    buffer_load_dwordx4 v1, s[8:11], s22 offen offset:3072 sc1 lds
    s_add_u32 s22, s22, 4096
    s_add_u32 s23, s23, 4096
    s_mov_b32 m0, s23
    s_nop 0
    buffer_load_dwordx4 v1, s[8:11], s22 offen offset:0 sc1 lds
    buffer_load_dwordx4 v1, s[8:11], s22 offen offset:1024 sc1 lds
    buffer_load_dwordx4 v1, s[8:11], s22 offen offset:2048 sc1 lds
    buffer_load_dwordx4 v1, s[8:11], s22 offen offset:3072 sc1 lds
    s_waitcnt vmcnt(0)
    s_barrier
    s_setprio 2
    s_cmp_ge_u32 s46, 2
    s_cbranch_scc1 L_qb_v_73
    ds_read_b128 v[48:51], v112 offset:0
    ds_read_b128 v[52:55], v112 offset:1024
    ds_read_b128 v[56:59], v112 offset:2048
    ds_read_b128 v[60:63], v112 offset:3072
    ds_read_b128 v[64:67], v112 offset:4096
    ds_read_b128 v[68:71], v112 offset:5120
    ds_read_b128 v[72:75], v112 offset:6144
    ds_read_b128 v[76:79], v112 offset:7168
    s_waitcnt lgkmcnt(7)
    v_mfma_f32_32x32x16_bf16 v[16:31], v[128:131], v[48:51], 0
    s_mov_b32 m0, s29
    s_nop 0
    buffer_load_dwordx4 v1, s[8:11], s24 offen offset:0 sc1 lds
    buffer_load_dwordx4 v1, s[8:11], s24 offen offset:1024 sc1 lds
    ds_read_b128 v[48:51], v112 offset:8192
    s_waitcnt lgkmcnt(7)
    v_mfma_f32_32x32x16_bf16 v[16:31], v[132:135], v[52:55], v[16:31]
    s_mov_b32 m0, s29
    s_nop 0
    buffer_load_dwordx4 v1, s[8:11], s24 offen offset:2048 sc1 lds
    buffer_load_dwordx4 v1, s[8:11], s24 offen offset:3072 sc1 lds
    ds_read_b128 v[52:55], v112 offset:9216
    s_waitcnt lgkmcnt(7)
    v_mfma_f32_32x32x16_bf16 v[16:31], v[136:139], v[56:59], v[16:31]
    s_add_u32 s24, s24, 4096
    s_add_u32 s29, s29, 4096
    s_mov_b32 m0, s29
    s_nop 0
    buffer_load_dwordx4 v1, s[8:11], s24 offen offset:0 sc1 lds
    buffer_load_dwordx4 v1, s[8:11], s24 offen offset:1024 sc1 lds
    ds_read_b128 v[56:59], v112 offset:10240
    s_waitcnt lgkmcnt(7)
    v_mfma_f32_32x32x16_bf16 v[16:31], v[140:143], v[60:63], v[16:31]
    s_mov_b32 m0, s29
    s_nop 0
    buffer_load_dwordx4 v1, s[8:11], s24 offen offset:2048 sc1 lds
    buffer_load_dwordx4 v1, s[8:11], s24 offen offset:3072 sc1 lds
    ds_read_b128 v[60:63], v112 offset:11264
    s_waitcnt lgkmcnt(7)
    v_mfma_f32_32x32x16_bf16 v[16:31], v[144:147], v[64:67], v[16:31]
    ds_read_b128 v[64:67], v112 offset:12288
    s_waitcnt lgkmcnt(7)
    v_mfma_f32_32x32x16_bf16 v[16:31], v[148:151], v[68:71], v[16:31]
    ds_read_b128 v[68:71], v112 offset:13312
    s_waitcnt lgkmcnt(7)
    v_mfma_f32_32x32x16_bf16 v[16:31], v[152:155], v[72:75], v[16:31]
    ds_read_b128 v[72:75], v112 offset:14336
    s_waitcnt lgkmcnt(7)
    v_mfma_f32_32x32x16_bf16 v[16:31], v[156:159], v[76:79], v[16:31]
    ds_read_b128 v[76:79], v112 offset:15360
    s_waitcnt lgkmcnt(7)
    v_mfma_f32_32x32x16_bf16 v[16:31], v[160:163], v[48:51], v[16:31]
    ds_read_b128 v[48:51], v112 offset:16384
    s_waitcnt lgkmcnt(7)
    v_mfma_f32_32x32x16_bf16 v[16:31], v[164:167], v[52:55], v[16:31]
    ds_read_b128 v[52:55], v112 offset:17408
    s_waitcnt lgkmcnt(7)
    v_mfma_f32_32x32x16_bf16 v[16:31], v[168:171], v[56:59], v[16:31]
    ds_read_b128 v[56:59], v112 offset:18432
    s_waitcnt lgkmcnt(7)
    v_mfma_f32_32x32x16_bf16 v[16:31], v[172:175], v[60:63], v[16:31]
    ds_read_b128 v[60:63], v112 offset:19456
    s_waitcnt lgkmcnt(7)
    v_mfma_f32_32x32x16_bf16 v[16:31], v[176:179], v[64:67], v[16:31]
    ds_read_b128 v[64:67], v112 offset:20480
    s_waitcnt lgkmcnt(7)
    v_mfma_f32_32x32x16_bf16 v[16:31], v[180:183], v[68:71], v[16:31]
    ds_read_b128 v[68:71], v112 offset:21504
    s_waitcnt lgkmcnt(7)
    v_mfma_f32_32x32x16_bf16 v[16:31], v[184:187], v[72:75], v[16:31]
    ds_read_b128 v[72:75], v112 offset:22528
    s_waitcnt lgkmcnt(7)
    v_mfma_f32_32x32x16_bf16 v[16:31], v[188:191], v[76:79], v[16:31]
    ds_read_b128 v[76:79], v112 offset:23552
    s_waitcnt lgkmcnt(7)
    v_mfma_f32_32x32x16_bf16 v[16:31], v[192:195], v[48:51], v[16:31]
    ds_read_b128 v[48:51], v112 offset:24576
    s_waitcnt lgkmcnt(7)
    v_mfma_f32_32x32x16_bf16 v[16:31], v[196:199], v[52:55], v[16:31]
    ds_read_b128 v[52:55], v112 offset:25600
    s_waitcnt lgkmcnt(7)
    v_mfma_f32_32x32x16_bf16 v[16:31], v[200:203], v[56:59], v[16:31]
    ds_read_b128 v[56:59], v112 offset:26624
    s_waitcnt lgkmcnt(7)
    v_mfma_f32_32x32x16_bf16 v[16:31], v[204:207], v[60:63], v[16:31]
    ds_read_b128 v[60:63], v112 offset:27648
    s_waitcnt lgkmcnt(7)
    v_mfma_f32_32x32x16_bf16 v[16:31], v[208:211], v[64:67], v[16:31]
    ds_read_b128 v[64:67], v112 offset:28672
    s_waitcnt lgkmcnt(7)
    v_mfma_f32_32x32x16_bf16 v[16:31], v[212:215], v[68:71], v[16:31]
    ds_read_b128 v[68:71], v112 offset:29696
    s_waitcnt lgkmcnt(7)
    v_mfma_f32_32x32x16_bf16 v[16:31], v[216:219], v[72:75], v[16:31]
    ds_read_b128 v[72:75], v112 offset:30720
    s_waitcnt lgkmcnt(7)
    v_mfma_f32_32x32x16_bf16 v[16:31], v[220:223], v[76:79], v[16:31]
    ds_read_b128 v[76:79], v112 offset:31744
    s_waitcnt lgkmcnt(7)
    v_mfma_f32_32x32x16_bf16 v[16:31], v[224:227], v[48:51], v[16:31]
    s_waitcnt vmcnt(0)
    s_barrier
    ds_read2_b32 v[114:115], v7 offset0:0 offset1:32
    ds_read2_b32 v[116:117], v7 offset0:64 offset1:96
    ds_read_b128 v[48:51], v112 offset:32768
    s_waitcnt lgkmcnt(9)
    v_mfma_f32_32x32x16_bf16 v[16:31], v[228:231], v[52:55], v[16:31]
    ds_read_b128 v[52:55], v112 offset:33792
    s_waitcnt lgkmcnt(9)
    v_mfma_f32_32x32x16_bf16 v[16:31], v[232:235], v[56:59], v[16:31]
    ds_read_b128 v[56:59], v112 offset:34816
    s_waitcnt lgkmcnt(9)
    v_mfma_f32_32x32x16_bf16 v[16:31], v[236:239], v[60:63], v[16:31]
    ds_read_b128 v[60:63], v112 offset:35840
    s_waitcnt lgkmcnt(9)
    v_mfma_f32_32x32x16_bf16 v[16:31], v[240:243], v[64:67], v[16:31]
    ds_read_b128 v[64:67], v112 offset:36864
    s_waitcnt lgkmcnt(9)
    v_mfma_f32_32x32x16_bf16 v[16:31], v[244:247], v[68:71], v[16:31]
    ds_read_b128 v[68:71], v112 offset:37888
    s_waitcnt lgkmcnt(9)
    v_mfma_f32_32x32x16_bf16 v[16:31], v[248:251], v[72:75], v[16:31]
    ds_read_b128 v[72:75], v112 offset:38912
    s_waitcnt lgkmcnt(9)
    v_mfma_f32_32x32x16_bf16 v[16:31], v[252:255], v[76:79], v[16:31]
    ds_read_b128 v[76:79], v112 offset:39936
    s_waitcnt lgkmcnt(7)
    v_mfma_f32_32x32x16_bf16 v[32:47], v[128:131], v[48:51], 0
    ds_read_b128 v[48:51], v112 offset:40960
    s_waitcnt lgkmcnt(7)
    v_mfma_f32_32x32x16_bf16 v[32:47], v[132:135], v[52:55], v[32:47]
    ds_read_b128 v[52:55], v112 offset:41984
    s_waitcnt lgkmcnt(7)
    v_mfma_f32_32x32x16_bf16 v[32:47], v[136:139], v[56:59], v[32:47]
    ds_read_b128 v[56:59], v112 offset:43008
    s_waitcnt lgkmcnt(7)
    v_mfma_f32_32x32x16_bf16 v[32:47], v[140:143], v[60:63], v[32:47]
    ds_read_b128 v[60:63], v112 offset:44032
    s_waitcnt lgkmcnt(7)
    v_mfma_f32_32x32x16_bf16 v[32:47], v[144:147], v[64:67], v[32:47]
    v_fma_f32 v16, -v114, v96, v16
    v_fma_f32 v17, -v114, v97, v17
    ds_read_b128 v[64:67], v112 offset:45056
    s_waitcnt lgkmcnt(7)
    v_mfma_f32_32x32x16_bf16 v[32:47], v[148:151], v[68:71], v[32:47]
    v_fma_f32 v18, -v114, v98, v18
    v_fma_f32 v19, -v114, v99, v19
    ds_read_b128 v[68:71], v112 offset:46080
    s_waitcnt lgkmcnt(7)
    v_mfma_f32_32x32x16_bf16 v[32:47], v[152:155], v[72:75], v[32:47]
    v_fma_f32 v20, -v114, v100, v20
    v_fma_f32 v21, -v114, v101, v21
    ds_read_b128 v[72:75], v112 offset:47104
    s_waitcnt lgkmcnt(7)
    v_mfma_f32_32x32x16_bf16 v[32:47], v[156:159], v[76:79], v[32:47]
    v_fma_f32 v22, -v114, v102, v22
    v_fma_f32 v23, -v114, v103, v23
    ds_read_b128 v[76:79], v112 offset:48128
    s_waitcnt lgkmcnt(7)
    v_mfma_f32_32x32x16_bf16 v[32:47], v[160:163], v[48:51], v[32:47]
    v_fma_f32 v24, -v114, v104, v24
    v_fma_f32 v25, -v114, v105, v25
    ds_read_b128 v[48:51], v112 offset:49152
    s_waitcnt lgkmcnt(7)
    v_mfma_f32_32x32x16_bf16 v[32:47], v[164:167], v[52:55], v[32:47]
    v_fma_f32 v26, -v114, v106, v26
    v_fma_f32 v27, -v114, v107, v27
    ds_read_b128 v[52:55], v112 offset:50176
    s_waitcnt lgkmcnt(7)
    v_mfma_f32_32x32x16_bf16 v[32:47], v[168:171], v[56:59], v[32:47]
    v_fma_f32 v28, -v114, v108, v28
    v_fma_f32 v29, -v114, v109, v29
    ds_read_b128 v[56:59], v112 offset:51200
    s_waitcnt lgkmcnt(7)
    v_mfma_f32_32x32x16_bf16 v[32:47], v[172:175], v[60:63], v[32:47]
    v_fma_f32 v30, -v114, v110, v30
    v_fma_f32 v31, -v114, v111, v31
    ds_read_b128 v[60:63], v112 offset:52224
    s_waitcnt lgkmcnt(7)
    v_mfma_f32_32x32x16_bf16 v[32:47], v[176:179], v[64:67], v[32:47]
    v_mul_f32 v16, v115, v16
    v_mul_f32 v17, v115, v17
    ds_read_b128 v[64:67], v112 offset:53248
    s_waitcnt lgkmcnt(7)
    v_mfma_f32_32x32x16_bf16 v[32:47], v[180:183], v[68:71], v[32:47]
    v_mul_f32 v18, v115, v18
    v_mul_f32 v19, v115, v19
    ds_read_b128 v[68:71], v112 offset:54272
    s_waitcnt lgkmcnt(7)
    v_mfma_f32_32x32x16_bf16 v[32:47], v[184:187], v[72:75], v[32:47]
    v_mul_f32 v20, v115, v20
    v_mul_f32 v21, v115, v21
    ds_read_b128 v[72:75], v112 offset:55296
    s_waitcnt lgkmcnt(7)
    v_mfma_f32_32x32x16_bf16 v[32:47], v[188:191], v[76:79], v[32:47]
    v_mul_f32 v22, v115, v22
    v_mul_f32 v23, v115, v23
    ds_read_b128 v[76:79], v112 offset:56320
    s_waitcnt lgkmcnt(7)
    v_mfma_f32_32x32x16_bf16 v[32:47], v[192:195], v[48:51], v[32:47]
    v_mul_f32 v24, v115, v24
    v_mul_f32 v25, v115, v25
    ds_read_b128 v[48:51], v112 offset:57344
    s_waitcnt lgkmcnt(7)
    v_mfma_f32_32x32x16_bf16 v[32:47], v[196:199], v[52:55], v[32:47]
    v_mul_f32 v26, v115, v26
    v_mul_f32 v27, v115, v27
    ds_read_b128 v[52:55], v112 offset:58368
    s_waitcnt lgkmcnt(7)
    v_mfma_f32_32x32x16_bf16 v[32:47], v[200:203], v[56:59], v[32:47]
    v_mul_f32 v28, v115, v28
    v_mul_f32 v29, v115, v29
    ds_read_b128 v[56:59], v112 offset:59392
    s_waitcnt lgkmcnt(7)
    v_mfma_f32_32x32x16_bf16 v[32:47], v[204:207], v[60:63], v[32:47]
    v_mul_f32 v30, v115, v30
    v_mul_f32 v31, v115, v31
    ds_read_b128 v[60:63], v112 offset:60416
    s_waitcnt lgkmcnt(7)
    v_mfma_f32_32x32x16_bf16 v[32:47], v[208:211], v[64:67], v[32:47]
    v_cvt_pk_bf16_f32 v16, v16, v17
    v_cvt_pk_bf16_f32 v17, v18, v19
    ds_read_b128 v[64:67], v112 offset:61440
    s_waitcnt lgkmcnt(7)
    v_mfma_f32_32x32x16_bf16 v[32:47], v[212:215], v[68:71], v[32:47]
    v_cvt_pk_bf16_f32 v18, v20, v21
    v_cvt_pk_bf16_f32 v19, v22, v23
    ds_read_b128 v[68:71], v112 offset:62464
    s_waitcnt lgkmcnt(7)
    v_mfma_f32_32x32x16_bf16 v[32:47], v[216:219], v[72:75], v[32:47]
    v_cvt_pk_bf16_f32 v20, v24, v25
    v_cvt_pk_bf16_f32 v21, v26, v27
    ds_read_b128 v[72:75], v112 offset:63488
    s_waitcnt lgkmcnt(7)
    v_mfma_f32_32x32x16_bf16 v[32:47], v[220:223], v[76:79], v[32:47]
    v_cvt_pk_bf16_f32 v22, v28, v29
    v_cvt_pk_bf16_f32 v23, v30, v31
    ds_read_b128 v[76:79], v112 offset:64512
    s_waitcnt lgkmcnt(7)
    v_mfma_f32_32x32x16_bf16 v[32:47], v[224:227], v[48:51], v[32:47]
    buffer_store_dwordx4 v[16:19], v118, s[8:11], s26 offen offset:0 sc0 sc1
    buffer_store_dwordx4 v[20:23], v118, s[8:11], s26 offen offset:2048 sc0 sc1
    s_waitcnt lgkmcnt(6)
    v_mfma_f32_32x32x16_bf16 v[32:47], v[228:231], v[52:55], v[32:47]
    ds_write_b128 v119, v[16:19] offset:8192
    ds_write_b128 v119, v[20:23] offset:10240
    s_waitcnt lgkmcnt(7)
    v_mfma_f32_32x32x16_bf16 v[32:47], v[232:235], v[56:59], v[32:47]
    s_waitcnt lgkmcnt(6)
    v_mfma_f32_32x32x16_bf16 v[32:47], v[236:239], v[60:63], v[32:47]
    s_waitcnt lgkmcnt(5)
    v_mfma_f32_32x32x16_bf16 v[32:47], v[240:243], v[64:67], v[32:47]
    s_waitcnt lgkmcnt(4)
    v_mfma_f32_32x32x16_bf16 v[32:47], v[244:247], v[68:71], v[32:47]
    s_mov_b64 exec, 1
    ds_add_u32 v120, v122 offset:80
    s_mov_b64 exec, -1
    s_waitcnt lgkmcnt(4)
    v_mfma_f32_32x32x16_bf16 v[32:47], v[248:251], v[72:75], v[32:47]
    s_waitcnt lgkmcnt(3)
    v_mfma_f32_32x32x16_bf16 v[32:47], v[252:255], v[76:79], v[32:47]
    s_nop 11
    v_fma_f32 v32, -v116, v96, v32
    v_fma_f32 v33, -v116, v97, v33
    v_fma_f32 v34, -v116, v98, v34
    v_fma_f32 v35, -v116, v99, v35
    v_fma_f32 v36, -v116, v100, v36
    v_fma_f32 v37, -v116, v101, v37
    v_fma_f32 v38, -v116, v102, v38
    v_fma_f32 v39, -v116, v103, v39
    v_fma_f32 v40, -v116, v104, v40
    v_fma_f32 v41, -v116, v105, v41
    v_fma_f32 v42, -v116, v106, v42
    v_fma_f32 v43, -v116, v107, v43
    v_fma_f32 v44, -v116, v108, v44
    v_fma_f32 v45, -v116, v109, v45
    v_fma_f32 v46, -v116, v110, v46
    v_fma_f32 v47, -v116, v111, v47
    v_mul_f32 v32, v117, v32
    v_mul_f32 v33, v117, v33
    v_mul_f32 v34, v117, v34
    v_mul_f32 v35, v117, v35
    v_mul_f32 v36, v117, v36
    v_mul_f32 v37, v117, v37
    v_mul_f32 v38, v117, v38
    v_mul_f32 v39, v117, v39
    v_mul_f32 v40, v117, v40
    v_mul_f32 v41, v117, v41
    v_mul_f32 v42, v117, v42
    v_mul_f32 v43, v117, v43
    v_mul_f32 v44, v117, v44
    v_mul_f32 v45, v117, v45
    v_mul_f32 v46, v117, v46
    v_mul_f32 v47, v117, v47
    v_cvt_pk_bf16_f32 v32, v32, v33
    v_cvt_pk_bf16_f32 v33, v34, v35
    v_cvt_pk_bf16_f32 v34, v36, v37
    v_cvt_pk_bf16_f32 v35, v38, v39
    v_cvt_pk_bf16_f32 v36, v40, v41
    v_cvt_pk_bf16_f32 v37, v42, v43
    v_cvt_pk_bf16_f32 v38, v44, v45
    v_cvt_pk_bf16_f32 v39, v46, v47
    buffer_store_dwordx4 v[32:35], v118, s[8:11], s27 offen offset:0 sc0 sc1
    buffer_store_dwordx4 v[36:39], v118, s[8:11], s27 offen offset:2048 sc0 sc1
    ds_write_b128 v119, v[32:35] offset:0
    ds_write_b128 v119, v[36:39] offset:2048
    s_branch L_qb_end_72
L_qb_v_73:
    ds_read_b128 v[48:51], v112 offset:0
    ds_read_b128 v[52:55], v112 offset:1024
    ds_read_b128 v[56:59], v112 offset:2048
    ds_read_b128 v[60:63], v112 offset:3072
    ds_read_b128 v[64:67], v112 offset:4096
    ds_read_b128 v[68:71], v112 offset:5120
    ds_read_b128 v[72:75], v112 offset:6144
    ds_read_b128 v[76:79], v112 offset:7168
    s_waitcnt lgkmcnt(7)
    v_mfma_f32_32x32x16_bf16 v[16:31], v[48:51], v[128:131], 0
    s_mov_b32 m0, s29
    s_nop 0
    buffer_load_dwordx4 v1, s[8:11], s24 offen offset:0 sc1 lds
    buffer_load_dwordx4 v1, s[8:11], s24 offen offset:1024 sc1 lds
    ds_read_b128 v[48:51], v112 offset:8192
    s_waitcnt lgkmcnt(7)
    v_mfma_f32_32x32x16_bf16 v[16:31], v[52:55], v[132:135], v[16:31]
    s_mov_b32 m0, s29
    s_nop 0
    buffer_load_dwordx4 v1, s[8:11], s24 offen offset:2048 sc1 lds
    buffer_load_dwordx4 v1, s[8:11], s24 offen offset:3072 sc1 lds
    ds_read_b128 v[52:55], v112 offset:9216
    s_waitcnt lgkmcnt(7)
    v_mfma_f32_32x32x16_bf16 v[16:31], v[56:59], v[136:139], v[16:31]
    s_add_u32 s24, s24, 4096
    s_add_u32 s29, s29, 4096
    s_mov_b32 m0, s29
    s_nop 0
    buffer_load_dwordx4 v1, s[8:11], s24 offen offset:0 sc1 lds
    buffer_load_dwordx4 v1, s[8:11], s24 offen offset:1024 sc1 lds
    ds_read_b128 v[56:59], v112 offset:10240
    s_waitcnt lgkmcnt(7)
    v_mfma_f32_32x32x16_bf16 v[16:31], v[60:63], v[140:143], v[16:31]
    s_mov_b32 m0, s29
    s_nop 0
    buffer_load_dwordx4 v1, s[8:11], s24 offen offset:2048 sc1 lds
    buffer_load_dwordx4 v1, s[8:11], s24 offen offset:3072 sc1 lds
    ds_read_b128 v[60:63], v112 offset:11264
    s_waitcnt lgkmcnt(7)
    v_mfma_f32_32x32x16_bf16 v[16:31], v[64:67], v[144:147], v[16:31]
    ds_read_b128 v[64:67], v112 offset:12288
    s_waitcnt lgkmcnt(7)
    v_mfma_f32_32x32x16_bf16 v[16:31], v[68:71], v[148:151], v[16:31]
    ds_read_b128 v[68:71], v112 offset:13312
    s_waitcnt lgkmcnt(7)
    v_mfma_f32_32x32x16_bf16 v[16:31], v[72:75], v[152:155], v[16:31]
    ds_read_b128 v[72:75], v112 offset:14336
    s_waitcnt lgkmcnt(7)
    v_mfma_f32_32x32x16_bf16 v[16:31], v[76:79], v[156:159], v[16:31]
    ds_read_b128 v[76:79], v112 offset:15360
    s_waitcnt lgkmcnt(7)
    v_mfma_f32_32x32x16_bf16 v[16:31], v[48:51], v[160:163], v[16:31]
    ds_read_b128 v[48:51], v112 offset:16384
    s_waitcnt lgkmcnt(7)
    v_mfma_f32_32x32x16_bf16 v[16:31], v[52:55], v[164:167], v[16:31]
    ds_read_b128 v[52:55], v112 offset:17408
    s_waitcnt lgkmcnt(7)
    v_mfma_f32_32x32x16_bf16 v[16:31], v[56:59], v[168:171], v[16:31]
    ds_read_b128 v[56:59], v112 offset:18432
    s_waitcnt lgkmcnt(7)
    v_mfma_f32_32x32x16_bf16 v[16:31], v[60:63], v[172:175], v[16:31]
    ds_read_b128 v[60:63], v112 offset:19456
    s_waitcnt lgkmcnt(7)
    v_mfma_f32_32x32x16_bf16 v[16:31], v[64:67], v[176:179], v[16:31]
    ds_read_b128 v[64:67], v112 offset:20480
    s_waitcnt lgkmcnt(7)
    v_mfma_f32_32x32x16_bf16 v[16:31], v[68:71], v[180:183], v[16:31]
    ds_read_b128 v[68:71], v112 offset:21504
    s_waitcnt lgkmcnt(7)
    v_mfma_f32_32x32x16_bf16 v[16:31], v[72:75], v[184:187], v[16:31]
    ds_read_b128 v[72:75], v112 offset:22528
    s_waitcnt lgkmcnt(7)
    v_mfma_f32_32x32x16_bf16 v[16:31], v[76:79], v[188:191], v[16:31]
    ds_read_b128 v[76:79], v112 offset:23552
    s_waitcnt lgkmcnt(7)
    v_mfma_f32_32x32x16_bf16 v[16:31], v[48:51], v[192:195], v[16:31]
    ds_read_b128 v[48:51], v112 offset:24576
    s_waitcnt lgkmcnt(7)
    v_mfma_f32_32x32x16_bf16 v[16:31], v[52:55], v[196:199], v[16:31]
    ds_read_b128 v[52:55], v112 offset:25600
    s_waitcnt lgkmcnt(7)
    v_mfma_f32_32x32x16_bf16 v[16:31], v[56:59], v[200:203], v[16:31]
    ds_read_b128 v[56:59], v112 offset:26624
    s_waitcnt lgkmcnt(7)
    v_mfma_f32_32x32x16_bf16 v[16:31], v[60:63], v[204:207], v[16:31]
    ds_read_b128 v[60:63], v112 offset:27648
    s_waitcnt lgkmcnt(7)
    v_mfma_f32_32x32x16_bf16 v[16:31], v[64:67], v[208:211], v[16:31]
    ds_read_b128 v[64:67], v112 offset:28672
    s_waitcnt lgkmcnt(7)
    v_mfma_f32_32x32x16_bf16 v[16:31], v[68:71], v[212:215], v[16:31]
    ds_read_b128 v[68:71], v112 offset:29696
    s_waitcnt lgkmcnt(7)
    v_mfma_f32_32x32x16_bf16 v[16:31], v[72:75], v[216:219], v[16:31]
    ds_read_b128 v[72:75], v112 offset:30720
    s_waitcnt lgkmcnt(7)
    v_mfma_f32_32x32x16_bf16 v[16:31], v[76:79], v[220:223], v[16:31]
    ds_read_b128 v[76:79], v112 offset:31744
    s_waitcnt lgkmcnt(7)
    v_mfma_f32_32x32x16_bf16 v[16:31], v[48:51], v[224:227], v[16:31]
    s_waitcnt vmcnt(0)
    s_barrier
    ds_read_b128 v[80:83], v7 offset:0
    ds_read_b128 v[96:99], v7 offset:128
    ds_read_b128 v[84:87], v7 offset:32
    ds_read_b128 v[100:103], v7 offset:160
    ds_read_b128 v[88:91], v7 offset:64
    ds_read_b128 v[104:107], v7 offset:192
    ds_read_b128 v[92:95], v7 offset:96
    ds_read_b128 v[108:111], v7 offset:224
    ds_read_b128 v[48:51], v112 offset:32768
    s_waitcnt lgkmcnt(15)
    v_mfma_f32_32x32x16_bf16 v[16:31], v[52:55], v[228:231], v[16:31]
    ds_read_b128 v[52:55], v112 offset:33792
    s_waitcnt lgkmcnt(15)
    v_mfma_f32_32x32x16_bf16 v[16:31], v[56:59], v[232:235], v[16:31]
    ds_read_b128 v[56:59], v112 offset:34816
    s_waitcnt lgkmcnt(15)
    v_mfma_f32_32x32x16_bf16 v[16:31], v[60:63], v[236:239], v[16:31]
    ds_read_b128 v[60:63], v112 offset:35840
    s_waitcnt lgkmcnt(15)
    v_mfma_f32_32x32x16_bf16 v[16:31], v[64:67], v[240:243], v[16:31]
    ds_read_b128 v[64:67], v112 offset:36864
    s_waitcnt lgkmcnt(15)
    v_mfma_f32_32x32x16_bf16 v[16:31], v[68:71], v[244:247], v[16:31]
    ds_read_b128 v[68:71], v112 offset:37888
    s_waitcnt lgkmcnt(15)
    v_mfma_f32_32x32x16_bf16 v[16:31], v[72:75], v[248:251], v[16:31]
    ds_read_b128 v[72:75], v112 offset:38912
    s_waitcnt lgkmcnt(15)
    v_mfma_f32_32x32x16_bf16 v[16:31], v[76:79], v[252:255], v[16:31]
    ds_read_b128 v[76:79], v112 offset:39936
    s_waitcnt lgkmcnt(7)
    v_mfma_f32_32x32x16_bf16 v[32:47], v[48:51], v[128:131], 0
    ds_read_b128 v[48:51], v112 offset:40960
    s_waitcnt lgkmcnt(7)
    v_mfma_f32_32x32x16_bf16 v[32:47], v[52:55], v[132:135], v[32:47]
    ds_read_b128 v[52:55], v112 offset:41984
    s_waitcnt lgkmcnt(7)
    v_mfma_f32_32x32x16_bf16 v[32:47], v[56:59], v[136:139], v[32:47]
    ds_read_b128 v[56:59], v112 offset:43008
    s_waitcnt lgkmcnt(7)
    v_mfma_f32_32x32x16_bf16 v[32:47], v[60:63], v[140:143], v[32:47]
    ds_read_b128 v[60:63], v112 offset:44032
    s_waitcnt lgkmcnt(7)
    v_mfma_f32_32x32x16_bf16 v[32:47], v[64:67], v[144:147], v[32:47]
    v_fma_f32 v16, -v80, v114, v16
    v_fma_f32 v17, -v81, v114, v17
    ds_read_b128 v[64:67], v112 offset:45056
    s_waitcnt lgkmcnt(7)
    v_mfma_f32_32x32x16_bf16 v[32:47], v[68:71], v[148:151], v[32:47]
    v_fma_f32 v18, -v82, v114, v18
    v_fma_f32 v19, -v83, v114, v19
    ds_read_b128 v[68:71], v112 offset:46080
    s_waitcnt lgkmcnt(7)
    v_mfma_f32_32x32x16_bf16 v[32:47], v[72:75], v[152:155], v[32:47]
    v_fma_f32 v20, -v84, v114, v20
    v_fma_f32 v21, -v85, v114, v21
    ds_read_b128 v[72:75], v112 offset:47104
    s_waitcnt lgkmcnt(7)
    v_mfma_f32_32x32x16_bf16 v[32:47], v[76:79], v[156:159], v[32:47]
    v_fma_f32 v22, -v86, v114, v22
    v_fma_f32 v23, -v87, v114, v23
    ds_read_b128 v[76:79], v112 offset:48128
    s_waitcnt lgkmcnt(7)
    v_mfma_f32_32x32x16_bf16 v[32:47], v[48:51], v[160:163], v[32:47]
    v_fma_f32 v24, -v88, v114, v24
    v_fma_f32 v25, -v89, v114, v25
    ds_read_b128 v[48:51], v112 offset:49152
    s_waitcnt lgkmcnt(7)
    v_mfma_f32_32x32x16_bf16 v[32:47], v[52:55], v[164:167], v[32:47]
    v_fma_f32 v26, -v90, v114, v26
    v_fma_f32 v27, -v91, v114, v27
    ds_read_b128 v[52:55], v112 offset:50176
    s_waitcnt lgkmcnt(7)
    v_mfma_f32_32x32x16_bf16 v[32:47], v[56:59], v[168:171], v[32:47]
    v_fma_f32 v28, -v92, v114, v28
    v_fma_f32 v29, -v93, v114, v29
    ds_read_b128 v[56:59], v112 offset:51200
    s_waitcnt lgkmcnt(7)
    v_mfma_f32_32x32x16_bf16 v[32:47], v[60:63], v[172:175], v[32:47]
    v_fma_f32 v30, -v94, v114, v30
    v_fma_f32 v31, -v95, v114, v31
    ds_read_b128 v[60:63], v112 offset:52224
    s_waitcnt lgkmcnt(7)
    v_mfma_f32_32x32x16_bf16 v[32:47], v[64:67], v[176:179], v[32:47]
    v_mul_f32 v16, v96, v16
    v_mul_f32 v17, v97, v17
    ds_read_b128 v[64:67], v112 offset:53248
    s_waitcnt lgkmcnt(7)
    v_mfma_f32_32x32x16_bf16 v[32:47], v[68:71], v[180:183], v[32:47]
    v_mul_f32 v18, v98, v18
    v_mul_f32 v19, v99, v19
    ds_read_b128 v[68:71], v112 offset:54272
    s_waitcnt lgkmcnt(7)
    v_mfma_f32_32x32x16_bf16 v[32:47], v[72:75], v[184:187], v[32:47]
    v_mul_f32 v20, v100, v20
    v_mul_f32 v21, v101, v21
    ds_read_b128 v[72:75], v112 offset:55296
    s_waitcnt lgkmcnt(7)
    v_mfma_f32_32x32x16_bf16 v[32:47], v[76:79], v[188:191], v[32:47]
    v_mul_f32 v22, v102, v22
    v_mul_f32 v23, v103, v23
    ds_read_b128 v[76:79], v112 offset:56320
    s_waitcnt lgkmcnt(7)
    v_mfma_f32_32x32x16_bf16 v[32:47], v[48:51], v[192:195], v[32:47]
    v_mul_f32 v24, v104, v24
    v_mul_f32 v25, v105, v25
    ds_read_b128 v[48:51], v112 offset:57344
    s_waitcnt lgkmcnt(7)
    v_mfma_f32_32x32x16_bf16 v[32:47], v[52:55], v[196:199], v[32:47]
    v_mul_f32 v26, v106, v26
    v_mul_f32 v27, v107, v27
    ds_read_b128 v[52:55], v112 offset:58368
    s_waitcnt lgkmcnt(7)
    v_mfma_f32_32x32x16_bf16 v[32:47], v[56:59], v[200:203], v[32:47]
    v_mul_f32 v28, v108, v28
    v_mul_f32 v29, v109, v29
    ds_read_b128 v[56:59], v112 offset:59392
    s_waitcnt lgkmcnt(7)
    v_mfma_f32_32x32x16_bf16 v[32:47], v[60:63], v[204:207], v[32:47]
    v_mul_f32 v30, v110, v30
    v_mul_f32 v31, v111, v31
    ds_read_b128 v[60:63], v112 offset:60416
    s_waitcnt lgkmcnt(7)
    v_mfma_f32_32x32x16_bf16 v[32:47], v[64:67], v[208:211], v[32:47]
    v_cvt_pk_bf16_f32 v16, v16, v17
    v_cvt_pk_bf16_f32 v17, v18, v19
    ds_read_b128 v[64:67], v112 offset:61440
    s_waitcnt lgkmcnt(7)
    v_mfma_f32_32x32x16_bf16 v[32:47], v[68:71], v[212:215], v[32:47]
    v_cvt_pk_bf16_f32 v18, v20, v21
    v_cvt_pk_bf16_f32 v19, v22, v23
    ds_read_b128 v[68:71], v112 offset:62464
    s_waitcnt lgkmcnt(7)
    v_mfma_f32_32x32x16_bf16 v[32:47], v[72:75], v[216:219], v[32:47]
    v_cvt_pk_bf16_f32 v20, v24, v25
    v_cvt_pk_bf16_f32 v21, v26, v27
    ds_read_b128 v[72:75], v112 offset:63488
    s_waitcnt lgkmcnt(7)
    v_mfma_f32_32x32x16_bf16 v[32:47], v[76:79], v[220:223], v[32:47]
    v_cvt_pk_bf16_f32 v22, v28, v29
    v_cvt_pk_bf16_f32 v23, v30, v31
    ds_read_b128 v[76:79], v112 offset:64512
    s_waitcnt lgkmcnt(7)
    v_mfma_f32_32x32x16_bf16 v[32:47], v[48:51], v[224:227], v[32:47]
    buffer_store_dwordx4 v[16:19], v118, s[8:11], s26 offen offset:1024 sc0 sc1
    buffer_store_dwordx4 v[20:23], v118, s[8:11], s26 offen offset:1536 sc0 sc1
    s_waitcnt lgkmcnt(6)
    v_mfma_f32_32x32x16_bf16 v[32:47], v[52:55], v[228:231], v[32:47]
    ds_write_b128 v119, v[16:19] offset:9216
    ds_write_b128 v119, v[20:23] offset:9728
    s_waitcnt lgkmcnt(7)
    v_mfma_f32_32x32x16_bf16 v[32:47], v[56:59], v[232:235], v[32:47]
    ds_read_b128 v[80:83], v7 offset:256
    ds_read_b128 v[96:99], v7 offset:384
    s_waitcnt lgkmcnt(8)
    v_mfma_f32_32x32x16_bf16 v[32:47], v[60:63], v[236:239], v[32:47]
    ds_read_b128 v[84:87], v7 offset:288
    ds_read_b128 v[100:103], v7 offset:416
    s_waitcnt lgkmcnt(9)
    v_mfma_f32_32x32x16_bf16 v[32:47], v[64:67], v[240:243], v[32:47]
    ds_read_b128 v[88:91], v7 offset:320
    ds_read_b128 v[104:107], v7 offset:448
    s_waitcnt lgkmcnt(10)
    v_mfma_f32_32x32x16_bf16 v[32:47], v[68:71], v[244:247], v[32:47]
    ds_read_b128 v[92:95], v7 offset:352
    ds_read_b128 v[108:111], v7 offset:480
    s_mov_b64 exec, 1
    ds_add_u32 v120, v122 offset:80
    s_mov_b64 exec, -1
    s_waitcnt lgkmcnt(12)
    v_mfma_f32_32x32x16_bf16 v[32:47], v[72:75], v[248:251], v[32:47]
    s_waitcnt lgkmcnt(11)
    v_mfma_f32_32x32x16_bf16 v[32:47], v[76:79], v[252:255], v[32:47]
    s_nop 10
    s_waitcnt lgkmcnt(0)
    v_fma_f32 v32, -v80, v114, v32
    v_fma_f32 v33, -v81, v114, v33
    v_fma_f32 v34, -v82, v114, v34
    v_fma_f32 v35, -v83, v114, v35
    v_fma_f32 v36, -v84, v114, v36
    v_fma_f32 v37, -v85, v114, v37
    v_fma_f32 v38, -v86, v114, v38
    v_fma_f32 v39, -v87, v114, v39
    v_fma_f32 v40, -v88, v114, v40
    v_fma_f32 v41, -v89, v114, v41
    v_fma_f32 v42, -v90, v114, v42
    v_fma_f32 v43, -v91, v114, v43
    v_fma_f32 v44, -v92, v114, v44
    v_fma_f32 v45, -v93, v114, v45
    v_fma_f32 v46, -v94, v114, v46
    v_fma_f32 v47, -v95, v114, v47
    v_mul_f32 v32, v96, v32
    v_mul_f32 v33, v97, v33
    v_mul_f32 v34, v98, v34
    v_mul_f32 v35, v99, v35
    v_mul_f32 v36, v100, v36
    v_mul_f32 v37, v101, v37
    v_mul_f32 v38, v102, v38
    v_mul_f32 v39, v103, v39
    v_mul_f32 v40, v104, v40
    v_mul_f32 v41, v105, v41
    v_mul_f32 v42, v106, v42
    v_mul_f32 v43, v107, v43
    v_mul_f32 v44, v108, v44
    v_mul_f32 v45, v109, v45
    v_mul_f32 v46, v110, v46
    v_mul_f32 v47, v111, v47
    v_cvt_pk_bf16_f32 v32, v32, v33
    v_cvt_pk_bf16_f32 v33, v34, v35
    v_cvt_pk_bf16_f32 v34, v36, v37
    v_cvt_pk_bf16_f32 v35, v38, v39
    v_cvt_pk_bf16_f32 v36, v40, v41
    v_cvt_pk_bf16_f32 v37, v42, v43
    v_cvt_pk_bf16_f32 v38, v44, v45
    v_cvt_pk_bf16_f32 v39, v46, v47
    buffer_store_dwordx4 v[32:35], v118, s[8:11], s27 offen offset:1024 sc0 sc1
    buffer_store_dwordx4 v[36:39], v118, s[8:11], s27 offen offset:1536 sc0 sc1
    ds_write_b128 v119, v[32:35] offset:1024
    ds_write_b128 v119, v[36:39] offset:1536
    s_branch L_qb_end_72
L_qb_L_71:
    s_add_u32 s24, s47, 81
    s_lshl_b32 s48, s24, 15
    s_add_u32 s49, s48, 4096
    s_add_u32 s50, s48, 8192
    s_add_u32 s51, s48, 12288
    s_add_u32 s52, s48, 16384
    s_add_u32 s53, s48, 20480
    s_add_u32 s54, s48, 24576
    s_add_u32 s55, s48, 28672
    s_lshr_b32 s26, s46, 1
    s_lshl_b32 s24, s17, 1
    s_add_u32 s24, s24, s26
    s_add_u32 s24, s24, 33
    s_lshl_b32 s38, s24, 7
    s_add_u32 s38, s38, 3211264
    v_lshlrev_b32 v4, 4, v3
    buffer_load_dwordx4 v[96:99], v4, s[8:11], s38 offen offset:0 sc1
    buffer_load_dwordx4 v[100:103], v4, s[8:11], s38 offen offset:32 sc1
    buffer_load_dwordx4 v[104:107], v4, s[8:11], s38 offen offset:64 sc1
    buffer_load_dwordx4 v[108:111], v4, s[8:11], s38 offen offset:96 sc1
    s_lshl_b32 s23, s26, 15
    s_add_u32 s23, s23, 0
    v_add_u32 v113, s23, v1
    s_lshl_b32 s23, s25, 15
    v_add_u32 v112, s23, v112
    s_lshl_b32 s22, s26, 12
    s_lshl_b32 s23, s25, 10
    s_add_u32 s22, s22, s23
    s_add_u32 s22, s22, 147456
    v_add_u32 v118, s22, v1
    v_lshlrev_b32 v7, 2, v2
    s_lshl_b32 s38, s25, 8
    s_add_u32 s38, s38, 155648
    v_add_u32 v7, s38, v7
    s_cmp_lt_u32 s46, 2
    s_cbranch_scc1 L_qb_q_74
    s_lshl_b32 s24, s16, 13
    s_lshl_b32 s23, s25, 12
    s_add_u32 s24, s24, s23
    s_add_u32 s24, s24, 3407872
    v_lshrrev_b32 v6, 2, v1
    s_lshl_b32 s39, s20, 2
    s_add_u32 s39, s39, 2
    s_bitcmp1_b32 s17, 0
    s_mov_b32 s42, 0xf0f0f0f0
    s_cselect_b32 s42, 0xf0f0f0f0, s42
    s_mov_b32 s43, s42
    v_lshrrev_b32 v4, 2, v1
    s_mov_b32 s40, 400000
    s_mov_b64 exec, s[42:43]
L_poll_79:
    buffer_load_dword v5, v4, s[8:11], s57 offen offset:0 sc1
    s_waitcnt vmcnt(0)
    v_cmp_gt_u32 vcc, s39, v5
    s_cbranch_vccz L_polled_80
    s_sleep 1
    s_sub_u32 s40, s40, 1
    s_cmp_lg_u32 s40, 0
    s_cbranch_scc1 L_poll_79
L_polled_80:
    s_mov_b64 exec, -1
    buffer_load_dword v48, v6, s[8:11], s24 offen offset:0 sc1
    buffer_load_dword v49, v6, s[8:11], s24 offen offset:256 sc1
    buffer_load_dword v50, v6, s[8:11], s24 offen offset:512 sc1
    buffer_load_dword v51, v6, s[8:11], s24 offen offset:768 sc1
    buffer_load_dword v52, v6, s[8:11], s24 offen offset:1024 sc1
    buffer_load_dword v53, v6, s[8:11], s24 offen offset:1280 sc1
    buffer_load_dword v54, v6, s[8:11], s24 offen offset:1536 sc1
    buffer_load_dword v55, v6, s[8:11], s24 offen offset:1792 sc1
    buffer_load_dword v56, v6, s[8:11], s24 offen offset:2048 sc1
    buffer_load_dword v57, v6, s[8:11], s24 offen offset:2304 sc1
    buffer_load_dword v58, v6, s[8:11], s24 offen offset:2560 sc1
    buffer_load_dword v59, v6, s[8:11], s24 offen offset:2816 sc1
    buffer_load_dword v60, v6, s[8:11], s24 offen offset:3072 sc1
    buffer_load_dword v61, v6, s[8:11], s24 offen offset:3328 sc1
    buffer_load_dword v62, v6, s[8:11], s24 offen offset:3584 sc1
    buffer_load_dword v63, v6, s[8:11], s24 offen offset:3840 sc1
    s_barrier
    v_lshlrev_b32 v4, 2, v2
    s_lshl_b32 s38, s25, 8
    s_add_u32 s38, s38, 155648
    v_add_u32 v4, s38, v4
    s_waitcnt vmcnt(0)
    v_add_f32 v48, v48, v56
    v_add_f32 v49, v49, v57
    v_add_f32 v50, v50, v58
    v_add_f32 v51, v51, v59
    v_add_f32 v52, v52, v60
    v_add_f32 v53, v53, v61
    v_add_f32 v54, v54, v62
    v_add_f32 v55, v55, v63
    v_add_f32 v48, v48, v52
    v_add_f32 v49, v49, v53
    v_add_f32 v50, v50, v54
    v_add_f32 v51, v51, v55
    v_add_f32 v48, v48, v50
    v_add_f32 v49, v49, v51
    v_add_f32 v48, v48, v49
    v_mul_f32 v48, 0x3b000000, v48
    v_mov_b32 v49, v48
    s_nop 1
    v_permlane32_swap_b32 v48, v49
    v_fma_f32 v49, -v48, v48, v49
    v_max_f32 v49, 0, v49
    v_add_f32 v49, 0x3727c5ac, v49
    v_rsq_f32 v49, v49
    ds_write_b32 v4, v48
    ds_write_b32 v4, v49 offset:128
    s_waitcnt lgkmcnt(0)
    s_branch L_qb_q2_81
L_qb_q_74:
    s_barrier
L_qb_q2_81:
    s_waitcnt vmcnt(0)
    s_barrier
    ds_read2_b32 v[114:115], v7 offset0:0 offset1:32
    buffer_load_dwordx4 v[128:131], v1, s[8:11], s48 offen offset:0 sc1
    buffer_load_dwordx4 v[132:135], v1, s[8:11], s48 offen offset:1024 sc1
    buffer_load_dwordx4 v[136:139], v1, s[8:11], s48 offen offset:2048 sc1
    buffer_load_dwordx4 v[140:143], v1, s[8:11], s48 offen offset:3072 sc1
    s_waitcnt vmcnt(4)
    buffer_load_dwordx4 v[144:147], v1, s[8:11], s49 offen offset:0 sc1
    buffer_load_dwordx4 v[148:151], v1, s[8:11], s49 offen offset:1024 sc1
    buffer_load_dwordx4 v[152:155], v1, s[8:11], s49 offen offset:2048 sc1
    buffer_load_dwordx4 v[156:159], v1, s[8:11], s49 offen offset:3072 sc1
    s_waitcnt vmcnt(4)
    buffer_load_dwordx4 v[160:163], v1, s[8:11], s50 offen offset:0 sc1
    buffer_load_dwordx4 v[164:167], v1, s[8:11], s50 offen offset:1024 sc1
    buffer_load_dwordx4 v[168:171], v1, s[8:11], s50 offen offset:2048 sc1
    buffer_load_dwordx4 v[172:175], v1, s[8:11], s50 offen offset:3072 sc1
    s_waitcnt vmcnt(4)
    buffer_load_dwordx4 v[176:179], v1, s[8:11], s51 offen offset:0 sc1
    buffer_load_dwordx4 v[180:183], v1, s[8:11], s51 offen offset:1024 sc1
    buffer_load_dwordx4 v[184:187], v1, s[8:11], s51 offen offset:2048 sc1
    buffer_load_dwordx4 v[188:191], v1, s[8:11], s51 offen offset:3072 sc1
    s_waitcnt vmcnt(4)
    buffer_load_dwordx4 v[192:195], v1, s[8:11], s52 offen offset:0 sc1
    buffer_load_dwordx4 v[196:199], v1, s[8:11], s52 offen offset:1024 sc1
    buffer_load_dwordx4 v[200:203], v1, s[8:11], s52 offen offset:2048 sc1
    buffer_load_dwordx4 v[204:207], v1, s[8:11], s52 offen offset:3072 sc1
    s_mov_b32 s30, 0x110000
    s_mov_b32 s31, 0x110000
    v_mov_b32 v32, 0x3f803f80
    v_cndmask_b32 v32, 0, v32, s[30:31]
    v_mov_b32 v33, v32
    v_mov_b32 v34, v32
    v_mov_b32 v35, v32
    v_mov_b32 v36, v32
    v_mov_b32 v37, v32
    v_mov_b32 v38, v32
    v_mov_b32 v39, v32
    v_mov_b32 v40, v32
    v_mov_b32 v41, v32
    v_mov_b32 v42, v32
    v_mov_b32 v43, v32
    v_mov_b32 v44, v32
    v_mov_b32 v45, v32
    v_mov_b32 v46, v32
    v_mov_b32 v47, v32
    s_mov_b32 s30, 0xffff
    s_mov_b32 s31, 0xffff
    s_lshr_b32 s25, s3, 2
    s_xor_b32 s26, s25, 1
    v_lshlrev_b32 v4, 3, v3
    v_sub_u32 v4, v2, v4
    s_cmp_eq_u32 s25, 0
    s_cselect_b32 s22, 0xf149f2ca, 0
    s_cselect_b32 s23, 0, 0xf149f2ca
    v_mov_b32 v5, s22
    v_mov_b32 v6, s23
    v_cmp_le_i32 s[36:37], 0, v4
    v_cmp_le_i32 s[38:39], 1, v4
    v_cmp_le_i32 s[40:41], 2, v4
    v_cndmask_b32 v64, v5, v6, s[36:37]
    v_cmp_le_i32 s[36:37], 3, v4
    v_cndmask_b32 v65, v5, v6, s[38:39]
    v_cmp_le_i32 s[38:39], 4, v4
    v_cndmask_b32 v66, v5, v6, s[40:41]
    v_cmp_le_i32 s[40:41], 5, v4
    v_cndmask_b32 v67, v5, v6, s[36:37]
    v_cmp_le_i32 s[36:37], 6, v4
    v_cndmask_b32 v68, v5, v6, s[38:39]
    v_cmp_le_i32 s[38:39], 7, v4
    v_cndmask_b32 v69, v5, v6, s[40:41]
    v_cmp_le_i32 s[40:41], 16, v4
    v_cndmask_b32 v70, v5, v6, s[36:37]
    v_cmp_le_i32 s[36:37], 17, v4
    v_cndmask_b32 v71, v5, v6, s[38:39]
    v_cmp_le_i32 s[38:39], 18, v4
    v_cndmask_b32 v72, v5, v6, s[40:41]
    v_cmp_le_i32 s[40:41], 19, v4
    v_cndmask_b32 v73, v5, v6, s[36:37]
    v_cmp_le_i32 s[36:37], 20, v4
    v_cndmask_b32 v74, v5, v6, s[38:39]
    v_cmp_le_i32 s[38:39], 21, v4
    v_cndmask_b32 v75, v5, v6, s[40:41]
    v_cmp_le_i32 s[40:41], 22, v4
    v_cndmask_b32 v76, v5, v6, s[36:37]
    v_cmp_le_i32 s[36:37], 23, v4
    v_cndmask_b32 v77, v5, v6, s[38:39]
    v_cndmask_b32 v78, v5, v6, s[40:41]
    v_cndmask_b32 v79, v5, v6, s[36:37]
    s_lshl_b32 s22, s26, 16
    s_lshl_b32 s23, s46, 11
    s_add_u32 s43, s22, s23
    s_lshl_b32 s22, s26, 10
    s_add_u32 s22, s22, s23
    s_add_u32 s22, s22, 147456
    v_add_u32 v6, s22, v1
    v_xor_b32 v7, 1024, v6
    s_lshl_b32 s22, s16, 1
    s_mul_i32 s23, s25, 3
    s_sub_i32 s22, s22, s23
    s_max_i32 s22, s22, 0
    s_min_i32 s27, s22, 3
    s_lshl_b32 s24, s59, 2
    s_lshl_b32 s42, s17, 19
    s_lshl_b32 s22, s16, 14
    s_add_u32 s42, s42, s22
    s_lshl_b32 s23, s46, 11
    s_add_u32 s42, s42, s23
    s_add_u32 s42, s42, s21
    s_add_u32 s42, s42, 12517376
    s_min_u32 s23, s16, 4
    s_lshl_b32 s44, 2, s23
    s_sub_u32 s44, s44, 1
    s_cmp_eq_u32 s25, 0
    s_cselect_b32 s22, 6, 28
    s_and_b32 s44, s44, s22
    s_mov_b32 s45, 0
L_cw_82:
    ds_read_b32 v4, v120 offset:80
    s_waitcnt lgkmcnt(0)
    v_readfirstlane_b32 s22, v4
    s_nop 0
    s_cmp_lt_u32 s22, s59
    s_cbranch_scc1 L_cw_82
    ds_read_b128 v[80:83], v113 offset:0
    ds_read_b128 v[48:51], v112 offset:0
    ds_read_b128 v[84:87], v113 offset:1024
    ds_read_b128 v[52:55], v112 offset:1024
    ds_read_b128 v[88:91], v113 offset:2048
    ds_read_b128 v[56:59], v112 offset:2048
    ds_read_b128 v[92:95], v113 offset:3072
    ds_read_b128 v[60:63], v112 offset:3072
    s_waitcnt lgkmcnt(6)
    v_mfma_f32_32x32x16_bf16 v[16:31], v[80:83], v[48:51], 0
    ds_read_b128 v[80:83], v113 offset:4096
    ds_read_b128 v[48:51], v112 offset:4096
    s_waitcnt lgkmcnt(6)
    v_mfma_f32_32x32x16_bf16 v[16:31], v[84:87], v[52:55], v[16:31]
    ds_read_b128 v[84:87], v113 offset:5120
    ds_read_b128 v[52:55], v112 offset:5120
    s_waitcnt lgkmcnt(6)
    v_mfma_f32_32x32x16_bf16 v[16:31], v[88:91], v[56:59], v[16:31]
    ds_read_b128 v[88:91], v113 offset:6144
    ds_read_b128 v[56:59], v112 offset:6144
    s_waitcnt lgkmcnt(6)
    v_mfma_f32_32x32x16_bf16 v[16:31], v[92:95], v[60:63], v[16:31]
    ds_read_b128 v[92:95], v113 offset:7168
    ds_read_b128 v[60:63], v112 offset:7168
    s_waitcnt lgkmcnt(6)
    v_mfma_f32_32x32x16_bf16 v[16:31], v[80:83], v[48:51], v[16:31]
    ds_read_b128 v[80:83], v113 offset:8192
    ds_read_b128 v[48:51], v112 offset:8192
    s_waitcnt lgkmcnt(6)
    v_mfma_f32_32x32x16_bf16 v[16:31], v[84:87], v[52:55], v[16:31]
    ds_read_b128 v[84:87], v113 offset:9216
    ds_read_b128 v[52:55], v112 offset:9216
    s_waitcnt lgkmcnt(6)
    v_mfma_f32_32x32x16_bf16 v[16:31], v[88:91], v[56:59], v[16:31]
    ds_read_b128 v[88:91], v113 offset:10240
    ds_read_b128 v[56:59], v112 offset:10240
    s_waitcnt lgkmcnt(6)
    v_mfma_f32_32x32x16_bf16 v[16:31], v[92:95], v[60:63], v[16:31]
    ds_read_b128 v[92:95], v113 offset:11264
    ds_read_b128 v[60:63], v112 offset:11264
    s_waitcnt lgkmcnt(6)
    v_mfma_f32_32x32x16_bf16 v[16:31], v[80:83], v[48:51], v[16:31]
    ds_read_b128 v[80:83], v113 offset:12288
    ds_read_b128 v[48:51], v112 offset:12288
    s_waitcnt lgkmcnt(6)
    v_mfma_f32_32x32x16_bf16 v[16:31], v[84:87], v[52:55], v[16:31]
    ds_read_b128 v[84:87], v113 offset:13312
    ds_read_b128 v[52:55], v112 offset:13312
    s_waitcnt lgkmcnt(6)
    v_mfma_f32_32x32x16_bf16 v[16:31], v[88:91], v[56:59], v[16:31]
    ds_read_b128 v[88:91], v113 offset:14336
    ds_read_b128 v[56:59], v112 offset:14336
    s_waitcnt lgkmcnt(6)
    v_mfma_f32_32x32x16_bf16 v[16:31], v[92:95], v[60:63], v[16:31]
    ds_read_b128 v[92:95], v113 offset:15360
    ds_read_b128 v[60:63], v112 offset:15360
    s_waitcnt lgkmcnt(6)
    v_mfma_f32_32x32x16_bf16 v[16:31], v[80:83], v[48:51], v[16:31]
    ds_read_b128 v[80:83], v113 offset:16384
    ds_read_b128 v[48:51], v112 offset:16384
    s_waitcnt lgkmcnt(6)
    v_mfma_f32_32x32x16_bf16 v[16:31], v[84:87], v[52:55], v[16:31]
    ds_read_b128 v[84:87], v113 offset:17408
    ds_read_b128 v[52:55], v112 offset:17408
    s_waitcnt lgkmcnt(6)
    v_mfma_f32_32x32x16_bf16 v[16:31], v[88:91], v[56:59], v[16:31]
    ds_read_b128 v[88:91], v113 offset:18432
    ds_read_b128 v[56:59], v112 offset:18432
    s_waitcnt lgkmcnt(6)
    v_mfma_f32_32x32x16_bf16 v[16:31], v[92:95], v[60:63], v[16:31]
    ds_read_b128 v[92:95], v113 offset:19456
    ds_read_b128 v[60:63], v112 offset:19456
    s_waitcnt lgkmcnt(6)
    v_mfma_f32_32x32x16_bf16 v[16:31], v[80:83], v[48:51], v[16:31]
    ds_read_b128 v[80:83], v113 offset:20480
    ds_read_b128 v[48:51], v112 offset:20480
    s_waitcnt lgkmcnt(6)
    v_mfma_f32_32x32x16_bf16 v[16:31], v[84:87], v[52:55], v[16:31]
    ds_read_b128 v[84:87], v113 offset:21504
    ds_read_b128 v[52:55], v112 offset:21504
    s_waitcnt lgkmcnt(6)
    v_mfma_f32_32x32x16_bf16 v[16:31], v[88:91], v[56:59], v[16:31]
    ds_read_b128 v[88:91], v113 offset:22528
    ds_read_b128 v[56:59], v112 offset:22528
    s_waitcnt lgkmcnt(6)
    v_mfma_f32_32x32x16_bf16 v[16:31], v[92:95], v[60:63], v[16:31]
    ds_read_b128 v[92:95], v113 offset:23552
    ds_read_b128 v[60:63], v112 offset:23552
    s_waitcnt lgkmcnt(6)
    v_mfma_f32_32x32x16_bf16 v[16:31], v[80:83], v[48:51], v[16:31]
    ds_read_b128 v[80:83], v113 offset:24576
    ds_read_b128 v[48:51], v112 offset:24576
    s_waitcnt lgkmcnt(6)
    v_mfma_f32_32x32x16_bf16 v[16:31], v[84:87], v[52:55], v[16:31]
    ds_read_b128 v[84:87], v113 offset:25600
    ds_read_b128 v[52:55], v112 offset:25600
    s_waitcnt lgkmcnt(6)
    v_mfma_f32_32x32x16_bf16 v[16:31], v[88:91], v[56:59], v[16:31]
    ds_read_b128 v[88:91], v113 offset:26624
    ds_read_b128 v[56:59], v112 offset:26624
    s_waitcnt lgkmcnt(6)
    v_mfma_f32_32x32x16_bf16 v[16:31], v[92:95], v[60:63], v[16:31]
    ds_read_b128 v[92:95], v113 offset:27648
    ds_read_b128 v[60:63], v112 offset:27648
    s_waitcnt lgkmcnt(6)
    v_mfma_f32_32x32x16_bf16 v[16:31], v[80:83], v[48:51], v[16:31]
    ds_read_b128 v[80:83], v113 offset:28672
    ds_read_b128 v[48:51], v112 offset:28672
    s_waitcnt lgkmcnt(6)
    v_mfma_f32_32x32x16_bf16 v[16:31], v[84:87], v[52:55], v[16:31]
    ds_read_b128 v[84:87], v113 offset:29696
    ds_read_b128 v[52:55], v112 offset:29696
    s_waitcnt lgkmcnt(6)
    v_mfma_f32_32x32x16_bf16 v[16:31], v[88:91], v[56:59], v[16:31]
    ds_read_b128 v[88:91], v113 offset:30720
    ds_read_b128 v[56:59], v112 offset:30720
    s_waitcnt lgkmcnt(6)
    v_mfma_f32_32x32x16_bf16 v[16:31], v[92:95], v[60:63], v[16:31]
    ds_read_b128 v[92:95], v113 offset:31744
    ds_read_b128 v[60:63], v112 offset:31744
    s_waitcnt lgkmcnt(6)
    v_mfma_f32_32x32x16_bf16 v[16:31], v[80:83], v[48:51], v[16:31]
    s_waitcnt lgkmcnt(4)
    v_mfma_f32_32x32x16_bf16 v[16:31], v[84:87], v[52:55], v[16:31]
    s_waitcnt lgkmcnt(2)
    v_mfma_f32_32x32x16_bf16 v[16:31], v[88:91], v[56:59], v[16:31]
    s_waitcnt lgkmcnt(0)
    v_mfma_f32_32x32x16_bf16 v[16:31], v[92:95], v[60:63], v[16:31]
    s_nop 10
    v_mul_f32 v115, 0x3eb8aa3b, v115
    v_fma_f32 v16, -v114, v96, v16
    v_fma_f32 v17, -v114, v97, v17
    v_fma_f32 v18, -v114, v98, v18
    v_fma_f32 v19, -v114, v99, v19
    v_fma_f32 v20, -v114, v100, v20
    v_fma_f32 v21, -v114, v101, v21
    v_fma_f32 v22, -v114, v102, v22
    v_fma_f32 v23, -v114, v103, v23
    v_fma_f32 v24, -v114, v104, v24
    v_fma_f32 v25, -v114, v105, v25
    v_fma_f32 v26, -v114, v106, v26
    v_fma_f32 v27, -v114, v107, v27
    v_fma_f32 v28, -v114, v108, v28
    v_fma_f32 v29, -v114, v109, v29
    v_fma_f32 v30, -v114, v110, v30
    v_fma_f32 v31, -v114, v111, v31
    v_mul_f32 v16, v115, v16
    v_mul_f32 v17, v115, v17
    v_mul_f32 v18, v115, v18
    v_mul_f32 v19, v115, v19
    v_mul_f32 v20, v115, v20
    v_mul_f32 v21, v115, v21
    v_mul_f32 v22, v115, v22
    v_mul_f32 v23, v115, v23
    v_mul_f32 v24, v115, v24
    v_mul_f32 v25, v115, v25
    v_mul_f32 v26, v115, v26
    v_mul_f32 v27, v115, v27
    v_mul_f32 v28, v115, v28
    v_mul_f32 v29, v115, v29
    v_mul_f32 v30, v115, v30
    v_mul_f32 v31, v115, v31
    v_cvt_pk_bf16_f32 v16, v16, v17
    v_cvt_pk_bf16_f32 v17, v18, v19
    v_cvt_pk_bf16_f32 v18, v20, v21
    v_cvt_pk_bf16_f32 v19, v22, v23
    v_cvt_pk_bf16_f32 v20, v24, v25
    v_cvt_pk_bf16_f32 v21, v26, v27
    v_cvt_pk_bf16_f32 v22, v28, v29
    v_cvt_pk_bf16_f32 v23, v30, v31
    ds_write_b128 v118, v[16:19] offset:0
    ds_write_b128 v118, v[20:23] offset:2048
    s_mov_b64 exec, 1
    ds_add_u32 v123, v122 offset:64
    s_mov_b64 exec, -1
L_qb_end_72:
    s_setprio 0
    s_waitcnt lgkmcnt(0)
    s_cmp_lt_u32 s3, 4
    s_cbranch_scc1 L_ab_p0_85
    s_mov_b32 s30, 0x110000
    s_mov_b32 s31, 0x110000
    v_mov_b32 v32, 0x3f803f80
    v_cndmask_b32 v32, 0, v32, s[30:31]
    v_mov_b32 v33, v32
    v_mov_b32 v34, v32
    v_mov_b32 v35, v32
    v_mov_b32 v36, v32
    v_mov_b32 v37, v32
    v_mov_b32 v38, v32
    v_mov_b32 v39, v32
    v_mov_b32 v40, v32
    v_mov_b32 v41, v32
    v_mov_b32 v42, v32
    v_mov_b32 v43, v32
    v_mov_b32 v44, v32
    v_mov_b32 v45, v32
    v_mov_b32 v46, v32
    v_mov_b32 v47, v32
    s_mov_b32 s30, 0xffff
    s_mov_b32 s31, 0xffff
    s_lshr_b32 s25, s3, 2
    s_xor_b32 s26, s25, 1
    v_lshlrev_b32 v4, 3, v3
    v_sub_u32 v4, v2, v4
    s_cmp_eq_u32 s25, 0
    s_cselect_b32 s22, 0xf149f2ca, 0
    s_cselect_b32 s23, 0, 0xf149f2ca
    v_mov_b32 v5, s22
    v_mov_b32 v6, s23
    v_cmp_le_i32 s[36:37], 0, v4
    v_cmp_le_i32 s[38:39], 1, v4
    v_cmp_le_i32 s[40:41], 2, v4
    v_cndmask_b32 v64, v5, v6, s[36:37]
    v_cmp_le_i32 s[36:37], 3, v4
    v_cndmask_b32 v65, v5, v6, s[38:39]
    v_cmp_le_i32 s[38:39], 4, v4
    v_cndmask_b32 v66, v5, v6, s[40:41]
    v_cmp_le_i32 s[40:41], 5, v4
    v_cndmask_b32 v67, v5, v6, s[36:37]
    v_cmp_le_i32 s[36:37], 6, v4
    v_cndmask_b32 v68, v5, v6, s[38:39]
    v_cmp_le_i32 s[38:39], 7, v4
    v_cndmask_b32 v69, v5, v6, s[40:41]
    v_cmp_le_i32 s[40:41], 16, v4
    v_cndmask_b32 v70, v5, v6, s[36:37]
    v_cmp_le_i32 s[36:37], 17, v4
    v_cndmask_b32 v71, v5, v6, s[38:39]
    v_cmp_le_i32 s[38:39], 18, v4
    v_cndmask_b32 v72, v5, v6, s[40:41]
    v_cmp_le_i32 s[40:41], 19, v4
    v_cndmask_b32 v73, v5, v6, s[36:37]
    v_cmp_le_i32 s[36:37], 20, v4
    v_cndmask_b32 v74, v5, v6, s[38:39]
    v_cmp_le_i32 s[38:39], 21, v4
    v_cndmask_b32 v75, v5, v6, s[40:41]
    v_cmp_le_i32 s[40:41], 22, v4
    v_cndmask_b32 v76, v5, v6, s[36:37]
    v_cmp_le_i32 s[36:37], 23, v4
    v_cndmask_b32 v77, v5, v6, s[38:39]
    v_cndmask_b32 v78, v5, v6, s[40:41]
    v_cndmask_b32 v79, v5, v6, s[36:37]
    s_lshl_b32 s22, s26, 16
    s_lshl_b32 s23, s46, 11
    s_add_u32 s43, s22, s23
    s_lshl_b32 s22, s26, 10
    s_add_u32 s22, s22, s23
    s_add_u32 s22, s22, 147456
    v_add_u32 v6, s22, v1
    v_xor_b32 v7, 1024, v6
    s_lshl_b32 s22, s16, 1
    s_mul_i32 s23, s25, 3
    s_sub_i32 s22, s22, s23
    s_max_i32 s22, s22, 0
    s_min_i32 s27, s22, 3
    s_lshl_b32 s24, s59, 2
    s_lshl_b32 s42, s17, 19
    s_lshl_b32 s22, s16, 14
    s_add_u32 s42, s42, s22
    s_lshl_b32 s23, s46, 11
    s_add_u32 s42, s42, s23
    s_add_u32 s42, s42, s21
    s_add_u32 s42, s42, 12517376
    s_min_u32 s23, s16, 4
    s_lshl_b32 s44, 2, s23
    s_sub_u32 s44, s44, 1
    s_cmp_eq_u32 s25, 0
    s_cselect_b32 s22, 6, 28
    s_and_b32 s44, s44, s22
    s_mov_b32 s45, 0
    v_mov_b32 v112, 0xdddddddd
    v_mov_b32 v80, 0
    v_mov_b32 v81, 0
    v_mov_b32 v82, 0
    v_mov_b32 v83, 0
    v_mov_b32 v84, 0
    v_mov_b32 v85, 0
    v_mov_b32 v86, 0
    v_mov_b32 v87, 0
    v_mov_b32 v88, 0
    v_mov_b32 v89, 0
    v_mov_b32 v90, 0
    v_mov_b32 v91, 0
    v_mov_b32 v92, 0
    v_mov_b32 v93, 0
    v_mov_b32 v94, 0
    v_mov_b32 v95, 0
    v_mov_b32 v96, 0
    v_mov_b32 v97, 0
    v_mov_b32 v98, 0
    v_mov_b32 v99, 0
    v_mov_b32 v100, 0
    v_mov_b32 v101, 0
    v_mov_b32 v102, 0
    v_mov_b32 v103, 0
    v_mov_b32 v104, 0
    v_mov_b32 v105, 0
    v_mov_b32 v106, 0
    v_mov_b32 v107, 0
    v_mov_b32 v108, 0
    v_mov_b32 v109, 0
    v_mov_b32 v110, 0
    v_mov_b32 v111, 0
    v_add_u32 v113, s43, v1
    v_and_b32 v114, 15, v2
    v_lshl_add_u32 v114, v3, 4, v114
    v_lshlrev_b32 v114, 4, v114
    v_add_u32 v114, s43, v114
    s_lshl_b32 s28, s17, 2
    s_add_u32 s28, s28, s46
    s_lshl_b32 s28, s28, 10
    s_lshl_b32 s22, s16, 16
    s_add_u32 s28, s28, s22
    s_add_u32 s28, s28, 8388608
    s_add_u32 s29, s28, 32768
    v_mul_u32_u24 v116, 4100, v2
    v_mov_b32 v117, s59
    s_sub_u32 s23, 31, s16
    s_min_u32 s23, s23, 4
    s_lshl_b32 s40, 2, s23
    s_sub_u32 s40, s40, 1
    s_mov_b32 s41, 0
    v_and_b32 v118, 7, v2
    v_lshlrev_b32 v118, 7, v118
    v_bfe_u32 v119, v2, 3, 1
    v_lshl_add_u32 v118, v119, 11, v118
    v_lshrrev_b32 v119, 4, v2
    v_lshl_add_u32 v119, v119, 13, v118
    s_mov_b64 exec, 1
    s_waitcnt vmcnt(0)
    ds_add_rtn_u32 v5, v123, v122 offset:20
    s_waitcnt lgkmcnt(0)
    v_readfirstlane_b32 s22, v5
    s_mov_b64 exec, -1
    s_nop 2
    s_and_b32 s22, s22, 3
    s_cmp_lg_u32 s22, 3
    s_cbranch_scc1 L_ab_sig_89
    s_mov_b64 exec, s[40:41]
    buffer_store_dword v117, v116, s[8:11], s57 offen offset:384 sc0 sc1
    s_mov_b64 exec, -1
L_ab_sig_89:
    s_and_b32 s22, s16, 3
    s_cmp_eq_u32 s22, 3
    s_cbranch_scc1 L_ab_t_90
    buffer_load_dword v48, v119, s[8:11], s60 offen sc1
L_ab_t_90:
    s_mul_i32 s22, s46, 4608
    s_add_u32 s22, s22, 40960
    v_add_u32 v116, s22, v1
    v_lshrrev_b32 v117, 2, v1
    v_add_u32 v117, s22, v117
    s_lshl_b32 s22, s46, 2
    v_add_u32 v118, s22, v123
L_cw_91:
    ds_read_b32 v119, v123 offset:64
    s_waitcnt lgkmcnt(0)
    v_readfirstlane_b32 s22, v119
    s_nop 0
    s_cmp_lt_u32 s22, s24
    s_cbranch_scc1 L_cw_91
    ds_read_b128 v[16:19], v6
    ds_read_b128 v[20:23], v7
    s_cmp_eq_u32 s44, 0
    s_cbranch_scc1 L_ab_np_93
    v_lshrrev_b32 v4, 2, v1
    s_mov_b32 s40, 400000
    s_mov_b64 exec, s[44:45]
L_poll_95:
    buffer_load_dword v5, v4, s[8:11], s57 offen offset:384 sc1
    s_waitcnt vmcnt(0)
    v_cmp_gt_u32 vcc, s59, v5
    s_cbranch_vccz L_polled_96
    s_sleep 1
    s_sub_u32 s40, s40, 1
    s_cmp_lg_u32 s40, 0
    s_cbranch_scc1 L_poll_95
L_polled_96:
    s_mov_b64 exec, -1
L_ab_np_93:
    s_add_u32 s22, s42, 0
    s_add_u32 s23, s43, 0
    s_mov_b32 m0, s23
    s_nop 0
    buffer_load_dwordx4 v1, s[8:11], s22 offen offset:0 sc1 lds
    buffer_load_dwordx4 v1, s[8:11], s22 offen offset:1024 sc1 lds
    s_add_u32 s22, s42, 8192
    s_add_u32 s23, s43, 8192
    s_mov_b32 m0, s23
    s_nop 0
    buffer_load_dwordx4 v1, s[8:11], s22 offen offset:0 sc1 lds
    buffer_load_dwordx4 v1, s[8:11], s22 offen offset:1024 sc1 lds
    s_add_u32 s22, s42, 16384
    s_add_u32 s23, s43, 16384
    s_mov_b32 m0, s23
    s_nop 0
    buffer_load_dwordx4 v1, s[8:11], s22 offen offset:0 sc1 lds
    buffer_load_dwordx4 v1, s[8:11], s22 offen offset:1024 sc1 lds
    s_add_u32 s22, s42, 24576
    s_add_u32 s23, s43, 24576
    s_mov_b32 m0, s23
    s_nop 0
    buffer_load_dwordx4 v1, s[8:11], s22 offen offset:0 sc1 lds
    buffer_load_dwordx4 v1, s[8:11], s22 offen offset:1024 sc1 lds
    s_add_u32 s22, s42, 32768
    s_add_u32 s23, s43, 32768
    s_mov_b32 m0, s23
    s_nop 0
    buffer_load_dwordx4 v1, s[8:11], s22 offen offset:0 sc1 lds
    buffer_load_dwordx4 v1, s[8:11], s22 offen offset:1024 sc1 lds
    s_cmp_lt_u32 s16, 4
    s_cbranch_scc1 L_ab_mid_88
    s_waitcnt vmcnt(6)
    s_branch L_ab_p1_86
L_ab_p0_85:
    v_mov_b32 v112, 0xdddddddd
    v_mov_b32 v80, 0
    v_mov_b32 v81, 0
    v_mov_b32 v82, 0
    v_mov_b32 v83, 0
    v_mov_b32 v84, 0
    v_mov_b32 v85, 0
    v_mov_b32 v86, 0
    v_mov_b32 v87, 0
    v_mov_b32 v88, 0
    v_mov_b32 v89, 0
    v_mov_b32 v90, 0
    v_mov_b32 v91, 0
    v_mov_b32 v92, 0
    v_mov_b32 v93, 0
    v_mov_b32 v94, 0
    v_mov_b32 v95, 0
    v_mov_b32 v96, 0
    v_mov_b32 v97, 0
    v_mov_b32 v98, 0
    v_mov_b32 v99, 0
    v_mov_b32 v100, 0
    v_mov_b32 v101, 0
    v_mov_b32 v102, 0
    v_mov_b32 v103, 0
    v_mov_b32 v104, 0
    v_mov_b32 v105, 0
    v_mov_b32 v106, 0
    v_mov_b32 v107, 0
    v_mov_b32 v108, 0
    v_mov_b32 v109, 0
    v_mov_b32 v110, 0
    v_mov_b32 v111, 0
    v_add_u32 v113, s43, v1
    v_and_b32 v114, 15, v2
    v_lshl_add_u32 v114, v3, 4, v114
    v_lshlrev_b32 v114, 4, v114
    v_add_u32 v114, s43, v114
    s_mul_i32 s22, s46, 4608
    s_add_u32 s22, s22, 40960
    v_add_u32 v116, s22, v1
    v_lshrrev_b32 v117, 2, v1
    v_add_u32 v117, s22, v117
    s_lshl_b32 s22, s46, 2
    v_add_u32 v118, s22, v123
L_cw_97:
    ds_read_b32 v119, v123 offset:20
    s_waitcnt lgkmcnt(0)
    v_readfirstlane_b32 s22, v119
    s_nop 0
    s_cmp_lt_u32 s22, s24
    s_cbranch_scc1 L_cw_97
L_cw_99:
    ds_read_b32 v119, v123 offset:64
    s_waitcnt lgkmcnt(0)
    v_readfirstlane_b32 s22, v119
    s_nop 0
    s_cmp_lt_u32 s22, s24
    s_cbranch_scc1 L_cw_99
    ds_read_b128 v[16:19], v6
    ds_read_b128 v[20:23], v7
L_ab_p1_86:
    ds_read_b128 v[24:27], v113 offset:0
    ds_read_b128 v[28:31], v113 offset:8192
    s_mov_b64 exec, s[30:31]
    ds_read_b128 v[32:35], v114 offset:1024
    ds_read_b128 v[36:39], v114 offset:1536
    s_mov_b64 exec, -1
    s_mov_b64 exec, s[30:31]
    ds_read_b128 v[40:43], v114 offset:9216
    ds_read_b128 v[44:47], v114 offset:9728
    s_mov_b64 exec, -1
    s_waitcnt lgkmcnt(5)
    v_mfma_f32_32x32x16_bf16 v[48:63], v[24:27], v[16:19], v[64:79]
    s_waitcnt lgkmcnt(4)
    v_mfma_f32_32x32x16_bf16 v[64:79], v[28:31], v[20:23], v[64:79]
    s_nop 9
    v_exp_f32 v48, v48
    v_exp_f32 v49, v49
    s_waitcnt lgkmcnt(0)
    v_exp_f32 v50, v50
    v_exp_f32 v51, v51
    v_exp_f32 v52, v52
    v_exp_f32 v53, v53
    v_exp_f32 v54, v54
    v_exp_f32 v55, v55
    v_exp_f32 v56, v56
    v_exp_f32 v57, v57
    v_exp_f32 v58, v58
    v_smfmac_f32_32x32x32_bf16 v[80:95], v[32:35], v[48:55], v112
    v_exp_f32 v59, v59
    v_exp_f32 v60, v60
    v_exp_f32 v61, v61
    v_exp_f32 v62, v62
    v_exp_f32 v63, v63
    v_exp_f32 v64, v64
    v_exp_f32 v65, v65
    v_smfmac_f32_32x32x32_bf16 v[80:95], v[36:39], v[56:63], v112
    s_waitcnt lgkmcnt(0)
    v_exp_f32 v66, v66
    v_exp_f32 v67, v67
    v_exp_f32 v68, v68
    v_mfma_f32_32x32x16_bf16 v[48:63], v[28:31], v[16:19], 0
    v_exp_f32 v69, v69
    v_exp_f32 v70, v70
    v_exp_f32 v71, v71
    v_exp_f32 v72, v72
    v_exp_f32 v73, v73
    v_exp_f32 v74, v74
    v_smfmac_f32_32x32x32_bf16 v[96:111], v[40:43], v[64:71], v112
    v_exp_f32 v75, v75
    v_exp_f32 v76, v76
    v_exp_f32 v77, v77
    v_exp_f32 v78, v78
    v_exp_f32 v79, v79
    v_exp_f32 v48, v48
    v_exp_f32 v49, v49
    v_smfmac_f32_32x32x32_bf16 v[96:111], v[44:47], v[72:79], v112
    s_waitcnt lgkmcnt(0)
    v_exp_f32 v50, v50
    v_exp_f32 v51, v51
    v_exp_f32 v52, v52
    v_exp_f32 v53, v53
    v_exp_f32 v54, v54
    v_exp_f32 v55, v55
    v_exp_f32 v56, v56
    v_exp_f32 v57, v57
    v_exp_f32 v58, v58
    v_smfmac_f32_32x32x32_bf16 v[80:95], v[40:43], v[48:55], v112
    v_exp_f32 v59, v59
    v_exp_f32 v60, v60
    v_exp_f32 v61, v61
    v_exp_f32 v62, v62
    v_exp_f32 v63, v63
    s_cmp_lg_u32 s25, 0
    s_nop 0
    v_smfmac_f32_32x32x32_bf16 v[80:95], v[44:47], v[56:63], v112
    s_cbranch_scc1 L_ab_p2_87
    s_cmp_eq_u32 s44, 0
    s_cbranch_scc1 L_ab_np_101
    v_lshrrev_b32 v4, 2, v1
    s_mov_b32 s40, 400000
    s_mov_b64 exec, s[44:45]
L_poll_103:
    buffer_load_dword v5, v4, s[8:11], s57 offen offset:384 sc1
    s_waitcnt vmcnt(0)
    v_cmp_gt_u32 vcc, s59, v5
    s_cbranch_vccz L_polled_104
    s_sleep 1
    s_sub_u32 s40, s40, 1
    s_cmp_lg_u32 s40, 0
    s_cbranch_scc1 L_poll_103
L_polled_104:
    s_mov_b64 exec, -1
L_ab_np_101:
    s_add_u32 s22, s42, 57344
    s_add_u32 s23, s43, 16384
    s_mov_b32 m0, s23
    s_nop 0
    buffer_load_dwordx4 v1, s[8:11], s22 offen offset:0 sc1 lds
    buffer_load_dwordx4 v1, s[8:11], s22 offen offset:1024 sc1 lds
    s_add_u32 s22, s42, 49152
    s_add_u32 s23, s43, 24576
    s_mov_b32 m0, s23
    s_nop 0
    buffer_load_dwordx4 v1, s[8:11], s22 offen offset:0 sc1 lds
    buffer_load_dwordx4 v1, s[8:11], s22 offen offset:1024 sc1 lds
    s_add_u32 s22, s42, 40960
    s_add_u32 s23, s43, 32768
    s_mov_b32 m0, s23
    s_nop 0
    buffer_load_dwordx4 v1, s[8:11], s22 offen offset:0 sc1 lds
    buffer_load_dwordx4 v1, s[8:11], s22 offen offset:1024 sc1 lds
L_ab_p2_87:
    s_lshl_b32 s22, s20, 1
    s_or_b32 s22, s22, s26
    s_cmp_eq_u32 s22, 0
    s_cselect_b64 vcc, -1, 0
    s_waitcnt vmcnt(0)
    s_cmp_eq_u32 s27, 0
    s_cbranch_scc1 L_ab_exit0
    ds_read_b128 v[24:27], v113 offset:16384
    s_mov_b64 exec, s[30:31]
    ds_read_b128 v[32:35], v114 offset:17408
    ds_read_b128 v[36:39], v114 offset:17920
    s_mov_b64 exec, -1
    s_waitcnt lgkmcnt(2)
    v_mfma_f32_32x32x16_bf16 v[64:79], v[24:27], v[20:23], 0
    s_nop 11
    v_exp_f32 v64, v64
    v_exp_f32 v65, v65
    s_waitcnt lgkmcnt(0)
    v_exp_f32 v66, v66
    v_exp_f32 v67, v67
    v_exp_f32 v68, v68
    v_mfma_f32_32x32x16_bf16 v[48:63], v[24:27], v[16:19], 0
    ds_read_b128 v[28:31], v113 offset:24576
    s_mov_b64 exec, s[30:31]
    ds_read_b128 v[40:43], v114 offset:25600
    ds_read_b128 v[44:47], v114 offset:26112
    s_mov_b64 exec, -1
    s_cbranch_vccz L_ab_pf_105
    buffer_load_dwordx4 v[128:131], v1, s[8:11], s48 offen offset:0 sc1
    buffer_load_dwordx4 v[132:135], v1, s[8:11], s48 offen offset:1024 sc1
    buffer_load_dwordx4 v[136:139], v1, s[8:11], s48 offen offset:2048 sc1
    buffer_load_dwordx4 v[140:143], v1, s[8:11], s48 offen offset:3072 sc1
    buffer_load_dwordx4 v[144:147], v1, s[8:11], s49 offen offset:0 sc1
    buffer_load_dwordx4 v[148:151], v1, s[8:11], s49 offen offset:1024 sc1
L_ab_pf_105:
    v_exp_f32 v69, v69
    v_exp_f32 v70, v70
    v_exp_f32 v71, v71
    v_exp_f32 v72, v72
    v_exp_f32 v73, v73
    v_exp_f32 v74, v74
    v_smfmac_f32_32x32x32_bf16 v[96:111], v[32:35], v[64:71], v112
    v_exp_f32 v75, v75
    v_exp_f32 v76, v76
    v_exp_f32 v77, v77
    v_exp_f32 v78, v78
    v_exp_f32 v79, v79
    v_exp_f32 v48, v48
    v_exp_f32 v49, v49
    v_smfmac_f32_32x32x32_bf16 v[96:111], v[36:39], v[72:79], v112
    s_waitcnt lgkmcnt(0)
    v_exp_f32 v50, v50
    v_exp_f32 v51, v51
    v_exp_f32 v52, v52
    v_mfma_f32_32x32x16_bf16 v[64:79], v[28:31], v[20:23], 0
    s_cmp_lg_u32 s25, 0
    s_cbranch_scc1 L_ab_wkv_106
    buffer_load_dwordx4 v[208:211], v1, s[8:11], s53 offen offset:0 sc1
    buffer_load_dwordx4 v[212:215], v1, s[8:11], s53 offen offset:1024 sc1
    buffer_load_dwordx4 v[216:219], v1, s[8:11], s53 offen offset:2048 sc1
    buffer_load_dwordx4 v[220:223], v1, s[8:11], s53 offen offset:3072 sc1
    buffer_load_dwordx4 v[224:227], v1, s[8:11], s54 offen offset:0 sc1
    buffer_load_dwordx4 v[228:231], v1, s[8:11], s54 offen offset:1024 sc1
    buffer_load_dwordx4 v[232:235], v1, s[8:11], s54 offen offset:2048 sc1
    buffer_load_dwordx4 v[236:239], v1, s[8:11], s54 offen offset:3072 sc1
    buffer_load_dwordx4 v[240:243], v1, s[8:11], s55 offen offset:0 sc1
    buffer_load_dwordx4 v[244:247], v1, s[8:11], s55 offen offset:1024 sc1
    buffer_load_dwordx4 v[248:251], v1, s[8:11], s55 offen offset:2048 sc1
    buffer_load_dwordx4 v[252:255], v1, s[8:11], s55 offen offset:3072 sc1
    s_lshr_b32 s22, s19, 1
    s_or_b32 s22, s22, s20
    s_cmp_lg_u32 s22, 0
    s_cbranch_scc1 L_ab_wkv_106
    s_lshl_b32 s23, s46, 13
    s_add_u32 s22, s23, 524288
    s_add_u32 s23, s23, 114688
    s_mov_b32 m0, s23
    s_nop 0
    buffer_load_dwordx4 v1, s[8:11], s22 offen offset:0 sc1 lds
    buffer_load_dwordx4 v1, s[8:11], s22 offen offset:1024 sc1 lds
    buffer_load_dwordx4 v1, s[8:11], s22 offen offset:2048 sc1 lds
    buffer_load_dwordx4 v1, s[8:11], s22 offen offset:3072 sc1 lds
    s_add_u32 s22, s22, 4096
    s_add_u32 s23, s23, 4096
    s_mov_b32 m0, s23
    s_nop 0
    buffer_load_dwordx4 v1, s[8:11], s22 offen offset:0 sc1 lds
    buffer_load_dwordx4 v1, s[8:11], s22 offen offset:1024 sc1 lds
    buffer_load_dwordx4 v1, s[8:11], s22 offen offset:2048 sc1 lds
    buffer_load_dwordx4 v1, s[8:11], s22 offen offset:3072 sc1 lds
L_ab_wkv_106:
    s_cbranch_vccz L_ab_pf_107
    buffer_load_dwordx4 v[152:155], v1, s[8:11], s49 offen offset:2048 sc1
    buffer_load_dwordx4 v[156:159], v1, s[8:11], s49 offen offset:3072 sc1
    buffer_load_dwordx4 v[160:163], v1, s[8:11], s50 offen offset:0 sc1
    buffer_load_dwordx4 v[164:167], v1, s[8:11], s50 offen offset:1024 sc1
    buffer_load_dwordx4 v[168:171], v1, s[8:11], s50 offen offset:2048 sc1
L_ab_pf_107:
    v_exp_f32 v53, v53
    v_exp_f32 v54, v54
    v_exp_f32 v55, v55
    v_exp_f32 v56, v56
    v_exp_f32 v57, v57
    v_exp_f32 v58, v58
    v_smfmac_f32_32x32x32_bf16 v[80:95], v[32:35], v[48:55], v112
    v_exp_f32 v59, v59
    v_exp_f32 v60, v60
    v_exp_f32 v61, v61
    v_exp_f32 v62, v62
    v_exp_f32 v63, v63
    s_cmp_eq_u32 s27, 1
    s_cbranch_scc1 L_ab_exit1
    v_exp_f32 v64, v64
    v_exp_f32 v65, v65
    v_smfmac_f32_32x32x32_bf16 v[80:95], v[36:39], v[56:63], v112
    s_waitcnt lgkmcnt(0)
    v_exp_f32 v66, v66
    v_exp_f32 v67, v67
    v_exp_f32 v68, v68
    v_mfma_f32_32x32x16_bf16 v[48:63], v[28:31], v[16:19], 0
    ds_read_b128 v[24:27], v113 offset:32768
    s_mov_b64 exec, s[30:31]
    ds_read_b128 v[32:35], v114 offset:33792
    ds_read_b128 v[36:39], v114 offset:34304
    s_mov_b64 exec, -1
    s_cbranch_vccz L_ab_pf_108
    buffer_load_dwordx4 v[172:175], v1, s[8:11], s50 offen offset:3072 sc1
    buffer_load_dwordx4 v[176:179], v1, s[8:11], s51 offen offset:0 sc1
    buffer_load_dwordx4 v[180:183], v1, s[8:11], s51 offen offset:1024 sc1
    buffer_load_dwordx4 v[184:187], v1, s[8:11], s51 offen offset:2048 sc1
    buffer_load_dwordx4 v[188:191], v1, s[8:11], s51 offen offset:3072 sc1
L_ab_pf_108:
    v_exp_f32 v69, v69
    v_exp_f32 v70, v70
    v_exp_f32 v71, v71
    v_exp_f32 v72, v72
    v_exp_f32 v73, v73
    v_exp_f32 v74, v74
    v_smfmac_f32_32x32x32_bf16 v[96:111], v[40:43], v[64:71], v112
    v_exp_f32 v75, v75
    v_exp_f32 v76, v76
    v_exp_f32 v77, v77
    v_exp_f32 v78, v78
    v_exp_f32 v79, v79
    v_exp_f32 v48, v48
    v_exp_f32 v49, v49
    v_smfmac_f32_32x32x32_bf16 v[96:111], v[44:47], v[72:79], v112
    s_waitcnt lgkmcnt(0)
    v_exp_f32 v50, v50
    v_exp_f32 v51, v51
    v_exp_f32 v52, v52
    v_mfma_f32_32x32x16_bf16 v[64:79], v[24:27], v[20:23], 0
    v_exp_f32 v53, v53
    v_exp_f32 v54, v54
    v_exp_f32 v55, v55
    v_exp_f32 v56, v56
    v_exp_f32 v57, v57
    v_exp_f32 v58, v58
    v_smfmac_f32_32x32x32_bf16 v[80:95], v[40:43], v[48:55], v112
    v_exp_f32 v59, v59
    v_exp_f32 v60, v60
    v_exp_f32 v61, v61
    v_exp_f32 v62, v62
    v_exp_f32 v63, v63
    s_cmp_eq_u32 s27, 2
    s_cbranch_scc1 L_ab_exit2
    v_exp_f32 v64, v64
    v_exp_f32 v65, v65
    v_smfmac_f32_32x32x32_bf16 v[80:95], v[44:47], v[56:63], v112
    s_waitcnt lgkmcnt(0)
    v_exp_f32 v66, v66
    v_exp_f32 v67, v67
    v_exp_f32 v68, v68
    v_mfma_f32_32x32x16_bf16 v[48:63], v[24:27], v[16:19], 0
    v_exp_f32 v69, v69
    v_exp_f32 v70, v70
    v_exp_f32 v71, v71
    v_exp_f32 v72, v72
    v_exp_f32 v73, v73
    v_exp_f32 v74, v74
    v_smfmac_f32_32x32x32_bf16 v[96:111], v[32:35], v[64:71], v112
    v_exp_f32 v75, v75
    v_exp_f32 v76, v76
    v_exp_f32 v77, v77
    v_exp_f32 v78, v78
    v_exp_f32 v79, v79
    v_exp_f32 v48, v48
    v_exp_f32 v49, v49
    v_smfmac_f32_32x32x32_bf16 v[96:111], v[36:39], v[72:79], v112
    s_waitcnt lgkmcnt(0)
    v_exp_f32 v50, v50
    v_exp_f32 v51, v51
    v_exp_f32 v52, v52
    v_exp_f32 v53, v53
    v_exp_f32 v54, v54
    v_exp_f32 v55, v55
    v_exp_f32 v56, v56
    v_exp_f32 v57, v57
    v_exp_f32 v58, v58
    v_smfmac_f32_32x32x32_bf16 v[80:95], v[32:35], v[48:55], v112
    v_exp_f32 v59, v59
    v_exp_f32 v60, v60
    v_exp_f32 v61, v61
    v_exp_f32 v62, v62
    v_exp_f32 v63, v63
    s_nop 1
    v_smfmac_f32_32x32x32_bf16 v[80:95], v[36:39], v[56:63], v112
L_ab_fin:
    s_cmp_ge_u32 s3, 4
    s_cbranch_scc1 L_fin_H_109
    s_nop 9
    ds_write_b128 v116, v[96:99] offset:0
    ds_write_b128 v116, v[100:103] offset:1024
    ds_write_b32 v117, v104 offset:2048
    ds_write_b128 v116, v[80:83] offset:2304
    ds_write_b128 v116, v[84:87] offset:3328
    ds_write_b32 v117, v88 offset:4352
    s_waitcnt lgkmcnt(0)
    s_mov_b64 exec, 1
    ds_add_u32 v118, v122 offset:32
    s_mov_b64 exec, -1
    s_branch L_ab_end_84
L_fin_H_109:
    s_lshl_b32 s23, s20, 1
    s_add_u32 s23, s23, 2
L_fin_w_110:
    ds_read_b32 v119, v118 offset:32
    ds_read_b128 v[24:27], v116 offset:0
    ds_read_b128 v[28:31], v116 offset:1024
    ds_read_b32 v6, v117 offset:2048
    ds_read_b128 v[32:35], v116 offset:2304
    ds_read_b128 v[36:39], v116 offset:3328
    ds_read_b32 v7, v117 offset:4352
    s_waitcnt lgkmcnt(6)
    v_readfirstlane_b32 s22, v119
    s_lshl_b32 s37, s20, 2
    s_add_u32 s37, s37, 3
    v_mov_b32 v5, s37
    v_lshlrev_b32 v4, 9, v2
    s_lshl_b32 s37, s16, 12
    s_lshl_b32 s44, s17, 5
    s_add_u32 s37, s37, s44
    s_lshl_b32 s44, s3, 2
    s_add_u32 s37, s37, s44
    s_add_u32 s37, s37, 42991616
    s_mov_b64 s[44:45], 0xff
    s_waitcnt lgkmcnt(0)
    s_cmp_lt_u32 s22, s23
    s_cbranch_scc1 L_fin_w_110
    v_add_f32 v88, v88, v6
    v_add_f32 v104, v104, v7
    v_pk_add_f32 v[80:81], v[80:81], v[24:25]
    v_pk_add_f32 v[82:83], v[82:83], v[26:27]
    v_pk_add_f32 v[84:85], v[84:85], v[28:29]
    v_pk_add_f32 v[86:87], v[86:87], v[30:31]
    v_pk_add_f32 v[96:97], v[96:97], v[32:33]
    v_pk_add_f32 v[98:99], v[98:99], v[34:35]
    v_pk_add_f32 v[100:101], v[100:101], v[36:37]
    v_pk_add_f32 v[102:103], v[102:103], v[38:39]
    v_cmp_nle_f32 vcc, 0x2b800000, v88
    s_mov_b64 s[40:41], vcc
    v_cmp_nge_f32 vcc, 0x53800000, v88
    s_or_b64 s[40:41], s[40:41], vcc
    v_cmp_nle_f32 vcc, 0x2b800000, v104
    s_or_b64 s[40:41], s[40:41], vcc
    v_cmp_nge_f32 vcc, 0x53800000, v104
    s_or_b64 s[40:41], s[40:41], vcc
    s_cbranch_scc1 L_ab_slow
L_ab_store:
    v_rcp_f32 v88, v88
    v_rcp_f32 v104, v104
    v_pk_mul_f32 v[80:81], v[80:81], v[88:89] op_sel_hi:[1,0]
    v_pk_mul_f32 v[82:83], v[82:83], v[88:89] op_sel_hi:[1,0]
    v_pk_mul_f32 v[84:85], v[84:85], v[88:89] op_sel_hi:[1,0]
    v_pk_mul_f32 v[86:87], v[86:87], v[88:89] op_sel_hi:[1,0]
    v_cvt_pk_bf16_f32 v80, v80, v81
    v_cvt_pk_bf16_f32 v81, v82, v83
    v_cvt_pk_bf16_f32 v82, v84, v85
    v_cvt_pk_bf16_f32 v83, v86, v87
    v_pk_mul_f32 v[96:97], v[96:97], v[104:105] op_sel_hi:[1,0]
    v_pk_mul_f32 v[98:99], v[98:99], v[104:105] op_sel_hi:[1,0]
    v_pk_mul_f32 v[100:101], v[100:101], v[104:105] op_sel_hi:[1,0]
    v_pk_mul_f32 v[102:103], v[102:103], v[104:105] op_sel_hi:[1,0]
    v_cvt_pk_bf16_f32 v96, v96, v97
    v_cvt_pk_bf16_f32 v97, v98, v99
    v_cvt_pk_bf16_f32 v98, v100, v101
    v_cvt_pk_bf16_f32 v99, v102, v103
    s_cmp_eq_u32 s56, 0
    s_cbranch_scc1 L_ts_111
    buffer_store_dwordx4 v[80:83], v1, s[8:11], s28 offen nt
    buffer_store_dwordx4 v[96:99], v1, s[8:11], s29 offen nt
    s_waitcnt vmcnt(0)
    s_mov_b64 exec, s[44:45]
    buffer_store_dword v5, v4, s[8:11], s37 offen nt
    s_mov_b64 exec, -1
L_ts_112:
L_ab_end_84:
    s_cmp_lt_u32 s3, 4
    s_cbranch_scc1 L_op_L_113
    s_waitcnt vmcnt(0)
    s_barrier
    s_branch L_op_end_114
L_op_L_113:
    s_waitcnt lgkmcnt(0)
    v_add_u32 v112, 32768, v1
    v_lshlrev_b32 v96, 16, v8
    v_and_b32 v97, 0xffff0000, v8
    v_lshlrev_b32 v98, 16, v9
    v_and_b32 v99, 0xffff0000, v9
    v_lshlrev_b32 v100, 16, v10
    v_and_b32 v101, 0xffff0000, v10
    v_lshlrev_b32 v102, 16, v11
    v_and_b32 v103, 0xffff0000, v11
    v_lshlrev_b32 v104, 16, v12
    v_and_b32 v105, 0xffff0000, v12
    v_lshlrev_b32 v106, 16, v13
    v_and_b32 v107, 0xffff0000, v13
    v_lshlrev_b32 v108, 16, v14
    v_and_b32 v109, 0xffff0000, v14
    v_lshlrev_b32 v110, 16, v15
    v_and_b32 v111, 0xffff0000, v15
    s_lshl_b32 s22, s18, 15
    s_lshl_b32 s23, s47, 11
    s_add_u32 s26, s22, s23
    s_add_u32 s26, s26, 4194304
    s_lshl_b32 s22, s18, 12
    s_lshl_b32 s23, s47, 8
    s_add_u32 s27, s22, s23
    s_add_u32 s27, s27, 3407872
    v_lshrrev_b32 v6, 2, v1
    s_lshl_b32 s37, s20, 2
    s_add_u32 s37, s37, 4
    v_mov_b32 v119, s37
    v_lshlrev_b32 v118, 9, v2
    s_lshl_b32 s37, s16, 12
    s_lshl_b32 s44, s17, 5
    s_add_u32 s37, s37, s44
    s_lshl_b32 s44, s3, 2
    s_add_u32 s37, s37, s44
    s_add_u32 s37, s37, 42991616
    s_and_b32 s44, s17, 1
    s_lshl_b32 s44, 0x55, s44
    s_mov_b32 s45, 0
    s_lshl_b32 s22, s18, 15
    s_lshl_b32 s23, s46, 13
    s_add_u32 s22, s22, s23
    s_add_u32 s22, s22, 8388608
    s_add_u32 s23, s23, 32768
    s_lshl_b32 s39, s20, 2
    s_add_u32 s39, s39, 3
    s_bitcmp1_b32 s17, 0
    s_mov_b32 s42, 0xf0f0f0f0
    s_cselect_b32 s42, 0xf0f0f0f0, s42
    s_mov_b32 s43, s42
    s_lshl_b32 s38, s46, 4
    s_lshl_b64 s[40:41], 0xffff, s38
    s_and_b64 s[42:43], s[42:43], s[40:41]
    s_lshl_b32 s38, s17, 3
    s_lshl_b64 s[40:41], 0xf0, s38
    s_or_b64 s[42:43], s[42:43], s[40:41]
    v_lshrrev_b32 v4, 2, v1
    s_mov_b32 s40, 400000
    s_mov_b64 exec, s[42:43]
L_poll_115:
    buffer_load_dword v5, v4, s[8:11], s57 offen offset:0 sc1
    s_waitcnt vmcnt(0)
    v_cmp_gt_u32 vcc, s39, v5
    s_cbranch_vccz L_polled_116
    s_sleep 1
    s_sub_u32 s40, s40, 1
    s_cmp_lg_u32 s40, 0
    s_cbranch_scc1 L_poll_115
L_polled_116:
    s_mov_b64 exec, -1
    s_mov_b32 m0, s23
    s_nop 0
    buffer_load_dwordx4 v1, s[8:11], s22 offen offset:0 sc1 lds
    buffer_load_dwordx4 v1, s[8:11], s22 offen offset:1024 sc1 lds
    buffer_load_dwordx4 v1, s[8:11], s22 offen offset:2048 sc1 lds
    buffer_load_dwordx4 v1, s[8:11], s22 offen offset:3072 sc1 lds
    s_add_u32 s22, s22, 4096
    s_add_u32 s23, s23, 4096
    s_mov_b32 m0, s23
    s_nop 0
    buffer_load_dwordx4 v1, s[8:11], s22 offen offset:0 sc1 lds
    buffer_load_dwordx4 v1, s[8:11], s22 offen offset:1024 sc1 lds
    buffer_load_dwordx4 v1, s[8:11], s22 offen offset:2048 sc1 lds
    buffer_load_dwordx4 v1, s[8:11], s22 offen offset:3072 sc1 lds
    s_waitcnt vmcnt(0)
    s_barrier
    ds_read_b128 v[48:51], v112 offset:0
    ds_read_b128 v[52:55], v112 offset:1024
    ds_read_b128 v[56:59], v112 offset:2048
    ds_read_b128 v[60:63], v112 offset:3072
    ds_read_b128 v[64:67], v112 offset:4096
    ds_read_b128 v[68:71], v112 offset:5120
    ds_read_b128 v[72:75], v112 offset:6144
    ds_read_b128 v[76:79], v112 offset:7168
    s_waitcnt lgkmcnt(7)
    v_mfma_f32_32x32x16_bf16 v[16:31], v[128:131], v[48:51], v[96:111]
    ds_read_b128 v[48:51], v112 offset:8192
    s_waitcnt lgkmcnt(7)
    v_mfma_f32_32x32x16_bf16 v[16:31], v[132:135], v[52:55], v[16:31]
    ds_read_b128 v[52:55], v112 offset:9216
    s_waitcnt lgkmcnt(7)
    v_mfma_f32_32x32x16_bf16 v[16:31], v[136:139], v[56:59], v[16:31]
    ds_read_b128 v[56:59], v112 offset:10240
    s_waitcnt lgkmcnt(7)
    v_mfma_f32_32x32x16_bf16 v[16:31], v[140:143], v[60:63], v[16:31]
    ds_read_b128 v[60:63], v112 offset:11264
    s_waitcnt lgkmcnt(7)
    v_mfma_f32_32x32x16_bf16 v[16:31], v[144:147], v[64:67], v[16:31]
    ds_read_b128 v[64:67], v112 offset:12288
    s_waitcnt lgkmcnt(7)
    v_mfma_f32_32x32x16_bf16 v[16:31], v[148:151], v[68:71], v[16:31]
    ds_read_b128 v[68:71], v112 offset:13312
    s_waitcnt lgkmcnt(7)
    v_mfma_f32_32x32x16_bf16 v[16:31], v[152:155], v[72:75], v[16:31]
    ds_read_b128 v[72:75], v112 offset:14336
    s_waitcnt lgkmcnt(7)
    v_mfma_f32_32x32x16_bf16 v[16:31], v[156:159], v[76:79], v[16:31]
    ds_read_b128 v[76:79], v112 offset:15360
    s_waitcnt lgkmcnt(7)
    v_mfma_f32_32x32x16_bf16 v[16:31], v[160:163], v[48:51], v[16:31]
    ds_read_b128 v[48:51], v112 offset:16384
    s_waitcnt lgkmcnt(7)
    v_mfma_f32_32x32x16_bf16 v[16:31], v[164:167], v[52:55], v[16:31]
    ds_read_b128 v[52:55], v112 offset:17408
    s_waitcnt lgkmcnt(7)
    v_mfma_f32_32x32x16_bf16 v[16:31], v[168:171], v[56:59], v[16:31]
    ds_read_b128 v[56:59], v112 offset:18432
    s_waitcnt lgkmcnt(7)
    v_mfma_f32_32x32x16_bf16 v[16:31], v[172:175], v[60:63], v[16:31]
    ds_read_b128 v[60:63], v112 offset:19456
    s_waitcnt lgkmcnt(7)
    v_mfma_f32_32x32x16_bf16 v[16:31], v[176:179], v[64:67], v[16:31]
    ds_read_b128 v[64:67], v112 offset:20480
    s_waitcnt lgkmcnt(7)
    v_mfma_f32_32x32x16_bf16 v[16:31], v[180:183], v[68:71], v[16:31]
    ds_read_b128 v[68:71], v112 offset:21504
    s_waitcnt lgkmcnt(7)
    v_mfma_f32_32x32x16_bf16 v[16:31], v[184:187], v[72:75], v[16:31]
    ds_read_b128 v[72:75], v112 offset:22528
    s_waitcnt lgkmcnt(7)
    v_mfma_f32_32x32x16_bf16 v[16:31], v[188:191], v[76:79], v[16:31]
    ds_read_b128 v[76:79], v112 offset:23552
    s_waitcnt lgkmcnt(7)
    v_mfma_f32_32x32x16_bf16 v[16:31], v[192:195], v[48:51], v[16:31]
    ds_read_b128 v[48:51], v112 offset:24576
    s_waitcnt lgkmcnt(7)
    v_mfma_f32_32x32x16_bf16 v[16:31], v[196:199], v[52:55], v[16:31]
    ds_read_b128 v[52:55], v112 offset:25600
    s_waitcnt lgkmcnt(7)
    v_mfma_f32_32x32x16_bf16 v[16:31], v[200:203], v[56:59], v[16:31]
    ds_read_b128 v[56:59], v112 offset:26624
    s_waitcnt lgkmcnt(7)
    v_mfma_f32_32x32x16_bf16 v[16:31], v[204:207], v[60:63], v[16:31]
    ds_read_b128 v[60:63], v112 offset:27648
    s_waitcnt lgkmcnt(7)
    v_mfma_f32_32x32x16_bf16 v[16:31], v[208:211], v[64:67], v[16:31]
    ds_read_b128 v[64:67], v112 offset:28672
    s_waitcnt lgkmcnt(7)
    v_mfma_f32_32x32x16_bf16 v[16:31], v[212:215], v[68:71], v[16:31]
    ds_read_b128 v[68:71], v112 offset:29696
    s_waitcnt lgkmcnt(7)
    v_mfma_f32_32x32x16_bf16 v[16:31], v[216:219], v[72:75], v[16:31]
    ds_read_b128 v[72:75], v112 offset:30720
    s_waitcnt lgkmcnt(7)
    v_mfma_f32_32x32x16_bf16 v[16:31], v[220:223], v[76:79], v[16:31]
    ds_read_b128 v[76:79], v112 offset:31744
    s_waitcnt lgkmcnt(7)
    v_mfma_f32_32x32x16_bf16 v[16:31], v[224:227], v[48:51], v[16:31]
    s_waitcnt lgkmcnt(6)
    v_mfma_f32_32x32x16_bf16 v[16:31], v[228:231], v[52:55], v[16:31]
    s_waitcnt lgkmcnt(5)
    v_mfma_f32_32x32x16_bf16 v[16:31], v[232:235], v[56:59], v[16:31]
    s_waitcnt lgkmcnt(4)
    v_mfma_f32_32x32x16_bf16 v[16:31], v[236:239], v[60:63], v[16:31]
    s_waitcnt lgkmcnt(3)
    v_mfma_f32_32x32x16_bf16 v[16:31], v[240:243], v[64:67], v[16:31]
    s_waitcnt lgkmcnt(2)
    v_mfma_f32_32x32x16_bf16 v[16:31], v[244:247], v[68:71], v[16:31]
    s_waitcnt lgkmcnt(1)
    v_mfma_f32_32x32x16_bf16 v[16:31], v[248:251], v[72:75], v[16:31]
    s_waitcnt lgkmcnt(0)
    v_mfma_f32_32x32x16_bf16 v[16:31], v[252:255], v[76:79], v[16:31]
    s_cmp_eq_u32 s20, 1
    s_cbranch_scc1 L_final
    s_nop 9
    v_cvt_pk_bf16_f32 v8, v16, v17
    v_cvt_pk_bf16_f32 v9, v18, v19
    v_cvt_pk_bf16_f32 v10, v20, v21
    v_cvt_pk_bf16_f32 v11, v22, v23
    v_cvt_pk_bf16_f32 v12, v24, v25
    v_cvt_pk_bf16_f32 v13, v26, v27
    v_cvt_pk_bf16_f32 v14, v28, v29
    v_cvt_pk_bf16_f32 v15, v30, v31
    s_cmp_eq_u32 s56, 0
    s_cbranch_scc1 L_ts_117
    buffer_store_dwordx4 v[8:11], v1, s[8:11], s26 offen nt
    buffer_store_dwordx4 v[12:15], v1, s[8:11], s26 offen offset:1024 nt
L_ts_118:
    v_pk_mul_f32 v[50:51], v[16:17], v[16:17]
    v_pk_add_f32 v[48:49], v[16:17], v[18:19]
    v_pk_fma_f32 v[50:51], v[18:19], v[18:19], v[50:51]
    v_pk_fma_f32 v[50:51], v[20:21], v[20:21], v[50:51]
    v_pk_add_f32 v[48:49], v[48:49], v[20:21]
    v_pk_fma_f32 v[50:51], v[22:23], v[22:23], v[50:51]
    v_pk_add_f32 v[48:49], v[48:49], v[22:23]
    v_pk_fma_f32 v[50:51], v[24:25], v[24:25], v[50:51]
    v_pk_add_f32 v[48:49], v[48:49], v[24:25]
    v_pk_fma_f32 v[50:51], v[26:27], v[26:27], v[50:51]
    v_pk_add_f32 v[48:49], v[48:49], v[26:27]
    v_pk_fma_f32 v[50:51], v[28:29], v[28:29], v[50:51]
    v_pk_add_f32 v[48:49], v[48:49], v[28:29]
    v_pk_fma_f32 v[50:51], v[30:31], v[30:31], v[50:51]
    v_pk_add_f32 v[48:49], v[48:49], v[30:31]
    v_add_f32 v48, v48, v49
    v_add_f32 v50, v50, v51
    s_nop 1
    v_permlane32_swap_b32 v48, v50
    v_add_f32 v48, v48, v50
    s_cmp_eq_u32 s56, 0
    s_cbranch_scc1 L_ts_119
    buffer_store_dword v48, v6, s[8:11], s27 offen nt
    s_mov_b64 exec, s[44:45]
    s_waitcnt vmcnt(1)
    buffer_store_dword v119, v118, s[8:11], s37 offen nt
    s_waitcnt vmcnt(1)
    buffer_store_dword v119, v118, s[8:11], s37 offen offset:16 nt
    s_mov_b64 exec, -1
L_ts_120:
L_op_end_114:
    s_add_u32 s20, s20, 1
    s_add_u32 s59, s59, 1
    s_add_u32 s21, s21, 13631488
    s_add_u32 s62, s62, 1
    s_cmp_lt_u32 s20, 2
    s_cbranch_scc1 L_iter
    s_lshl_b32 s22, s2, 3
    s_add_u32 s22, s22, s3
    s_cmp_lg_u32 s22, 4
    s_cbranch_scc1 L_end_main
    s_add_u32 s22, s58, 64
    v_mov_b32 v4, s22
    v_mov_b32 v5, 0
    s_mov_b32 s23, 42467328
    s_mov_b64 exec, 1
    buffer_store_dword v4, v5, s[8:11], s23 offen
    s_endpgm
L_final:
    v_lshlrev_b32 v118, 10, v2
    v_lshl_add_u32 v118, v3, 4, v118
    s_lshl_b32 s22, s18, 15
    s_lshl_b32 s23, s47, 6
    s_add_u32 s22, s22, s23
    s_nop 4
    v_cvt_pk_bf16_f32 v8, v16, v17
    v_cvt_pk_bf16_f32 v9, v18, v19
    v_cvt_pk_bf16_f32 v10, v20, v21
    v_cvt_pk_bf16_f32 v11, v22, v23
    v_cvt_pk_bf16_f32 v12, v24, v25
    v_cvt_pk_bf16_f32 v13, v26, v27
    v_cvt_pk_bf16_f32 v14, v28, v29
    v_cvt_pk_bf16_f32 v15, v30, v31
    v_permlane32_swap_b32 v8, v10
    v_permlane32_swap_b32 v9, v11
    v_permlane32_swap_b32 v12, v14
    v_permlane32_swap_b32 v13, v15
    buffer_store_dwordx4 v[8:11], v118, s[12:15], s22 offen offset:0 nt
    buffer_store_dwordx4 v[12:15], v118, s[12:15], s22 offen offset:32 nt
L_end_main:
    s_endpgm
.p2align 6
L_aa_body:
    v_exp_f32 v48, v48
    v_exp_f32 v49, v49
    v_smfmac_f32_32x32x32_bf16 v[96:111], v[44:47], v[72:79], v112
    s_waitcnt lgkmcnt(0)
    v_exp_f32 v50, v50
    v_exp_f32 v51, v51
    v_exp_f32 v52, v52
    v_mfma_f32_32x32x16_bf16 v[64:79], v[24:27], v[20:23], 0
    ds_read_b128 v[24:27], v113 offset:8192
    s_mov_b64 exec, s[30:31]
    ds_read_b128 v[40:43], v114 offset:4096
    ds_read_b128 v[44:47], v114 offset:4608
    s_mov_b64 exec, -1
    v_exp_f32 v53, v53
    v_exp_f32 v54, v54
    v_exp_f32 v55, v55
    v_exp_f32 v56, v56
    v_exp_f32 v57, v57
    v_exp_f32 v58, v58
    v_smfmac_f32_32x32x32_bf16 v[80:95], v[32:35], v[48:55], v112
    v_exp_f32 v59, v59
    v_exp_f32 v60, v60
    v_exp_f32 v61, v61
    v_exp_f32 v62, v62
    v_exp_f32 v63, v63
    v_exp_f32 v64, v64
    v_exp_f32 v65, v65
    v_smfmac_f32_32x32x32_bf16 v[80:95], v[36:39], v[56:63], v112
    v_exp_f32 v66, v66
    v_exp_f32 v67, v67
    v_exp_f32 v68, v68
    v_mfma_f32_32x32x16_bf16 v[48:63], v[28:31], v[16:19], 0
    v_exp_f32 v69, v69
    v_exp_f32 v70, v70
    v_exp_f32 v71, v71
    v_exp_f32 v72, v72
    v_exp_f32 v73, v73
    v_exp_f32 v74, v74
    v_smfmac_f32_32x32x32_bf16 v[96:111], v[32:35], v[64:71], v112
    v_exp_f32 v75, v75
    v_exp_f32 v76, v76
    v_exp_f32 v77, v77
    v_exp_f32 v78, v78
    v_exp_f32 v79, v79
    v_exp_f32 v48, v48
    v_exp_f32 v49, v49
    v_smfmac_f32_32x32x32_bf16 v[96:111], v[36:39], v[72:79], v112
    s_waitcnt lgkmcnt(0)
    v_exp_f32 v50, v50
    v_exp_f32 v51, v51
    v_exp_f32 v52, v52
    v_mfma_f32_32x32x16_bf16 v[64:79], v[28:31], v[20:23], 0
    ds_read_b128 v[28:31], v113 offset:12288
    s_mov_b64 exec, s[30:31]
    ds_read_b128 v[32:35], v114 offset:8192
    ds_read_b128 v[36:39], v114 offset:8704
    s_mov_b64 exec, -1
    v_exp_f32 v53, v53
    v_exp_f32 v54, v54
    v_exp_f32 v55, v55
    v_exp_f32 v56, v56
    v_exp_f32 v57, v57
    v_exp_f32 v58, v58
    v_smfmac_f32_32x32x32_bf16 v[80:95], v[40:43], v[48:55], v112
    v_exp_f32 v59, v59
    v_exp_f32 v60, v60
    v_exp_f32 v61, v61
    v_exp_f32 v62, v62
    v_exp_f32 v63, v63
    v_exp_f32 v64, v64
    v_exp_f32 v65, v65
    v_smfmac_f32_32x32x32_bf16 v[80:95], v[44:47], v[56:63], v112
    v_exp_f32 v66, v66
    v_exp_f32 v67, v67
    v_exp_f32 v68, v68
    v_mfma_f32_32x32x16_bf16 v[48:63], v[24:27], v[16:19], 0
    v_exp_f32 v69, v69
    v_exp_f32 v70, v70
    v_exp_f32 v71, v71
    v_exp_f32 v72, v72
    v_exp_f32 v73, v73
    v_exp_f32 v74, v74
    v_smfmac_f32_32x32x32_bf16 v[96:111], v[40:43], v[64:71], v112
    v_exp_f32 v75, v75
    v_exp_f32 v76, v76
    v_exp_f32 v77, v77
    v_exp_f32 v78, v78
    v_exp_f32 v79, v79
    v_exp_f32 v48, v48
    v_exp_f32 v49, v49
    v_smfmac_f32_32x32x32_bf16 v[96:111], v[44:47], v[72:79], v112
    s_waitcnt lgkmcnt(0)
    v_exp_f32 v50, v50
    v_exp_f32 v51, v51
    v_exp_f32 v52, v52
    v_mfma_f32_32x32x16_bf16 v[64:79], v[24:27], v[20:23], 0
    ds_read_b128 v[24:27], v113 offset:16384
    s_mov_b64 exec, s[30:31]
    ds_read_b128 v[40:43], v114 offset:12288
    ds_read_b128 v[44:47], v114 offset:12800
    s_mov_b64 exec, -1
    v_exp_f32 v53, v53
    v_exp_f32 v54, v54
    v_exp_f32 v55, v55
    v_exp_f32 v56, v56
    v_exp_f32 v57, v57
    v_exp_f32 v58, v58
    v_smfmac_f32_32x32x32_bf16 v[80:95], v[32:35], v[48:55], v112
    v_exp_f32 v59, v59
    v_exp_f32 v60, v60
    v_exp_f32 v61, v61
    v_exp_f32 v62, v62
    v_exp_f32 v63, v63
    v_exp_f32 v64, v64
    v_exp_f32 v65, v65
    v_smfmac_f32_32x32x32_bf16 v[80:95], v[36:39], v[56:63], v112
    v_exp_f32 v66, v66
    v_exp_f32 v67, v67
    v_exp_f32 v68, v68
    v_mfma_f32_32x32x16_bf16 v[48:63], v[28:31], v[16:19], 0
    v_exp_f32 v69, v69
    v_exp_f32 v70, v70
    v_exp_f32 v71, v71
    v_exp_f32 v72, v72
    v_exp_f32 v73, v73
    v_exp_f32 v74, v74
    v_smfmac_f32_32x32x32_bf16 v[96:111], v[32:35], v[64:71], v112
    v_exp_f32 v75, v75
    v_exp_f32 v76, v76
    v_exp_f32 v77, v77
    v_exp_f32 v78, v78
    v_exp_f32 v79, v79
    v_exp_f32 v48, v48
    v_exp_f32 v49, v49
    v_smfmac_f32_32x32x32_bf16 v[96:111], v[36:39], v[72:79], v112
    s_waitcnt lgkmcnt(0)
    v_exp_f32 v50, v50
    v_exp_f32 v51, v51
    v_exp_f32 v52, v52
    v_mfma_f32_32x32x16_bf16 v[64:79], v[28:31], v[20:23], 0
    ds_read_b128 v[28:31], v113 offset:20480
    s_mov_b64 exec, s[30:31]
    ds_read_b128 v[32:35], v114 offset:16384
    ds_read_b128 v[36:39], v114 offset:16896
    s_mov_b64 exec, -1
    v_exp_f32 v53, v53
    v_exp_f32 v54, v54
    v_exp_f32 v55, v55
    v_exp_f32 v56, v56
    v_exp_f32 v57, v57
    v_exp_f32 v58, v58
    v_smfmac_f32_32x32x32_bf16 v[80:95], v[40:43], v[48:55], v112
    v_exp_f32 v59, v59
    v_exp_f32 v60, v60
    v_exp_f32 v61, v61
    v_exp_f32 v62, v62
    v_exp_f32 v63, v63
    v_exp_f32 v64, v64
    v_exp_f32 v65, v65
    v_smfmac_f32_32x32x32_bf16 v[80:95], v[44:47], v[56:63], v112
    v_exp_f32 v66, v66
    v_exp_f32 v67, v67
    v_exp_f32 v68, v68
    v_mfma_f32_32x32x16_bf16 v[48:63], v[24:27], v[16:19], 0
    v_exp_f32 v69, v69
    v_exp_f32 v70, v70
    v_exp_f32 v71, v71
    v_exp_f32 v72, v72
    v_exp_f32 v73, v73
    v_exp_f32 v74, v74
    v_smfmac_f32_32x32x32_bf16 v[96:111], v[40:43], v[64:71], v112
    v_exp_f32 v75, v75
    v_exp_f32 v76, v76
    v_exp_f32 v77, v77
    v_exp_f32 v78, v78
    v_exp_f32 v79, v79
    v_add_u32 v113, 16384, v113
    v_add_u32 v114, 16384, v114
    s_setpc_b64 s[34:35]
L_st_prep_4:
    s_lshl_b32 s43, s18, 1
    s_add_u32 s43, s43, s19
    s_sub_u32 s43, s43, 2
    s_cmp_eq_u32 s46, 0
    s_cselect_b32 s12, s72, s78
    s_cselect_b32 s13, s73, s79
    s_cmp_ge_u32 s46, 2
    s_cselect_b32 s12, s76, s12
    s_cselect_b32 s13, s77, s13
    s_movk_i32 s23, 4096
    s_cselect_b32 s23, 6144, s23
    s_cselect_b32 s22, 1, 0
    s_lshl_b32 s27, s43, s22
    s_and_b32 s22, s22, s46
    s_add_u32 s27, s27, s22
    s_mul_i32 s27, s27, s23
    s_add_u32 s14, s27, s23
    s_mov_b32 s15, 0x20000
    v_lshlrev_b32 v21, 3, v1
    buffer_load_dword v161, v21, s[12:15], s27 offen
    s_cmp_ge_u32 s43, 97
    s_cbranch_scc1 L_st_none_3
    s_mov_b32 s41, 1
    s_mov_b32 s28, 32
    s_mov_b32 s42, 0
    s_cmp_eq_u32 s43, 16
    s_cbranch_scc1 L_st_src_121
    s_mov_b32 s82, 0x80000
    s_mov_b32 s28, 1024
    s_mov_b32 s80, s60
    s_mov_b32 s81, s61
    s_lshl_b32 s42, s43, 6
    s_cmp_lt_u32 s43, 16
    s_cbranch_scc1 L_st_src_121
    s_mov_b32 s80, s72
    s_mov_b32 s81, s73
    s_sub_u32 s42, s43, 17
    s_lshl_b32 s42, s42, 6
    s_cmp_lt_u32 s43, 33
    s_cbranch_scc1 L_st_src_121
    s_mov_b32 s80, s78
    s_mov_b32 s81, s79
    s_sub_u32 s42, s43, 81
    s_lshl_b32 s42, s42, 6
    s_cmp_ge_u32 s43, 81
    s_cbranch_scc1 L_st_src_121
    s_mov_b32 s80, s76
    s_mov_b32 s81, s77
    s_mov_b32 s82, 0x180000
    s_mov_b32 s28, 3072
    s_sub_u32 s42, s43, 33
    s_lshl_b32 s42, s42, 6
L_st_src_121:
    v_lshrrev_b32 v160, 6, v1
    v_mul_lo_u32 v160, v160, s28
    s_cmp_eq_u32 s28, 32
    s_cselect_b32 s23, 16, 48
    v_and_b32 v21, s23, v1
    v_add_u32 v160, v160, v21
    s_lshl_b32 s23, s46, 7
    s_mul_i32 s23, s23, s28
    s_add_u32 s42, s42, s23
    s_lshl_b32 s38, s28, 4
    s_branch L_st_none_3
L_qa_st_32:
    s_lshl_b32 s39, s20, 2
    s_add_u32 s39, s39, 0
    s_bitcmp1_b32 s17, 0
    s_mov_b32 s42, 0xf000f0
    s_cselect_b32 s42, 0xf000f000, s42
    s_mov_b32 s43, s42
    v_lshrrev_b32 v4, 2, v1
    s_mov_b32 s40, 400000
    s_mov_b64 exec, s[42:43]
L_poll_122:
    buffer_load_dword v5, v4, s[8:11], s57 offen offset:0 sc1
    s_waitcnt vmcnt(0)
    v_cmp_gt_u32 vcc, s39, v5
    s_cbranch_vccz L_polled_123
    s_sleep 1
    s_sub_u32 s40, s40, 1
    s_cmp_lg_u32 s40, 0
    s_cbranch_scc1 L_poll_122
L_polled_123:
    s_mov_b64 exec, -1
    buffer_load_dword v48, v6, s[8:11], s24 offen offset:0 sc1
    buffer_load_dword v49, v6, s[8:11], s24 offen offset:256 sc1
    buffer_load_dword v50, v6, s[8:11], s24 offen offset:512 sc1
    buffer_load_dword v51, v6, s[8:11], s24 offen offset:768 sc1
    buffer_load_dword v52, v6, s[8:11], s24 offen offset:1024 sc1
    buffer_load_dword v53, v6, s[8:11], s24 offen offset:1280 sc1
    buffer_load_dword v54, v6, s[8:11], s24 offen offset:1536 sc1
    buffer_load_dword v55, v6, s[8:11], s24 offen offset:1792 sc1
    buffer_load_dword v56, v6, s[8:11], s24 offen offset:2048 sc1
    buffer_load_dword v57, v6, s[8:11], s24 offen offset:2304 sc1
    buffer_load_dword v58, v6, s[8:11], s24 offen offset:2560 sc1
    buffer_load_dword v59, v6, s[8:11], s24 offen offset:2816 sc1
    buffer_load_dword v60, v6, s[8:11], s24 offen offset:3072 sc1
    buffer_load_dword v61, v6, s[8:11], s24 offen offset:3328 sc1
    buffer_load_dword v62, v6, s[8:11], s24 offen offset:3584 sc1
    buffer_load_dword v63, v6, s[8:11], s24 offen offset:3840 sc1
    s_barrier
    v_lshlrev_b32 v4, 2, v2
    s_mov_b32 s38, 155648
    v_add_u32 v4, s38, v4
    s_waitcnt vmcnt(0)
    v_add_f32 v48, v48, v56
    v_add_f32 v49, v49, v57
    v_add_f32 v50, v50, v58
    v_add_f32 v51, v51, v59
    v_add_f32 v52, v52, v60
    v_add_f32 v53, v53, v61
    v_add_f32 v54, v54, v62
    v_add_f32 v55, v55, v63
    v_add_f32 v48, v48, v52
    v_add_f32 v49, v49, v53
    v_add_f32 v50, v50, v54
    v_add_f32 v51, v51, v55
    v_add_f32 v48, v48, v50
    v_add_f32 v49, v49, v51
    v_add_f32 v48, v48, v49
    v_mul_f32 v48, 0x3b000000, v48
    v_mov_b32 v49, v48
    s_nop 1
    v_permlane32_swap_b32 v48, v49
    v_fma_f32 v49, -v48, v48, v49
    v_max_f32 v49, 0, v49
    v_add_f32 v49, 0x3727c5ac, v49
    v_rsq_f32 v49, v49
    ds_write_b32 v4, v48
    ds_write_b32 v4, v49 offset:128
    s_waitcnt lgkmcnt(0)
    s_branch L_qa_st_33
L_ts_61:
    buffer_store_dwordx4 v[80:83], v1, s[8:11], s28 offen sc0 sc1
    buffer_store_dwordx4 v[96:99], v1, s[8:11], s29 offen sc0 sc1
    s_waitcnt vmcnt(0)
    s_mov_b64 exec, s[44:45]
    buffer_store_dword v5, v4, s[8:11], s37 offen sc0 sc1
    s_mov_b64 exec, -1
    s_branch L_ts_62
L_aa_slow:
    s_getpc_b64 s[32:33]
L_pc_124:
    s_add_u32 s32, s32, L_slow-L_pc_124
    s_addc_u32 s33, s33, 0
    s_add_u32 s24, s21, 16777216
    s_mov_b32 s25, 2048
    s_mov_b32 s26, 63
    s_mov_b32 s27, 0
    v_mov_b32 v28, v20
    v_mov_b32 v29, v21
    v_mov_b32 v30, v22
    v_mov_b32 v31, v23
    s_swappc_b64 s[34:35], s[32:33]
    v_mov_b32 v96, v80
    v_mov_b32 v97, v81
    v_mov_b32 v98, v82
    v_mov_b32 v99, v83
    v_mov_b32 v100, v84
    v_mov_b32 v101, v85
    v_mov_b32 v102, v86
    v_mov_b32 v103, v87
    v_mov_b32 v104, v88
    s_add_u32 s24, s21, 16777216
    s_mov_b32 s25, 2048
    s_mov_b32 s26, 63
    s_mov_b32 s27, 0
    v_mov_b32 v28, v16
    v_mov_b32 v29, v17
    v_mov_b32 v30, v18
    v_mov_b32 v31, v19
    s_swappc_b64 s[34:35], s[32:33]
    s_branch L_aa_store
L_aa_arr:
    s_cmp_lg_u32 s3, 0
    s_cbranch_scc1 L_aa_arr_ret
    s_lshr_b32 s37, s18, 3
    s_mul_i32 s37, s37, 4352
    s_and_b32 s23, s18, 7
    s_lshl_b32 s23, s23, 2
    s_add_u32 s23, s23, s19
    s_lshl_b32 s23, s23, 3
    s_add_u32 s37, s37, s23
    s_add_u32 s37, s37, 42082560
    v_mov_b32 v4, s62
    v_mov_b32 v5, s63
    v_mov_b32 v6, 0
    s_mov_b64 exec, 1
    s_waitcnt vmcnt(0)
    buffer_store_dwordx2 v[4:5], v6, s[8:11], s37 offen sc0 sc1
    s_mov_b64 exec, -1
    s_branch L_aa_arr_ret
L_aa_lead:
    s_and_b32 s22, s18, 7
    s_lshl_b32 s22, s22, 5
    s_lshl_b32 s23, s19, 3
    s_add_u32 s22, s22, s23
    s_add_u32 s22, s22, s3
    s_cmp_lg_u32 s22, 9
    s_cbranch_scc1 L_aa_lead_ret
    s_lshr_b32 s23, s18, 3
    s_mul_i32 s38, s23, 4352
    s_add_u32 s38, s38, 42082560
    s_lshl_b32 s23, s23, 3
    s_add_u32 s23, s23, 41943104
    s_mov_b32 s44, -1
    s_mov_b32 s45, 0
    v_mul_u32_u24 v119, 4352, v2
    v_lshrrev_b32 v7, 1, v1
    s_mov_b32 s40, 400000
    s_mov_b64 exec, s[44:45]
L_poll_125:
    buffer_load_dwordx2 v[4:5], v7, s[8:11], s38 offen sc1
    s_waitcnt vmcnt(0)
    v_cmp_ne_u64 vcc, s[62:63], v[4:5]
    s_cbranch_vccz L_polled_126
    s_sleep 1
    s_sub_u32 s40, s40, 1
    s_cmp_lg_u32 s40, 0
    s_cbranch_scc1 L_poll_125
L_polled_126:
    s_mov_b64 exec, -1
    v_mov_b32 v4, s62
    v_mov_b32 v5, s63
    s_mov_b32 exec_hi, 0
    buffer_store_dwordx2 v[4:5], v119, s[8:11], s23 offen sc0 sc1
    s_mov_b64 exec, -1
    s_branch L_aa_lead_ret
L_aa_warm:
    s_cmp_lg_u32 s3, 2
    s_cbranch_scc1 L_aa_wr_127
    s_mul_i32 s38, s16, 4352
    s_add_u32 s38, s38, 41943104
    v_lshrrev_b32 v7, 1, v1
    s_mov_b32 s40, 400000
    s_mov_b64 exec, 0xff
L_poll_128:
    buffer_load_dwordx2 v[4:5], v7, s[8:11], s38 offen sc1
    s_waitcnt vmcnt(0)
    v_cmp_ne_u64 vcc, s[62:63], v[4:5]
    s_cbranch_vccz L_polled_129
    s_sleep 4
    s_sub_u32 s40, s40, 1
    s_cmp_lg_u32 s40, 0
    s_cbranch_scc1 L_poll_128
L_polled_129:
    s_mov_b64 exec, -1
    v_lshrrev_b32 v4, 2, v1
    s_mov_b64 exec, 0xff
    buffer_load_dword v5, v4, s[8:11], s38 offen offset:64 sc1
    s_waitcnt vmcnt(0)
    v_readfirstlane_b32 s22, v5
    s_nop 1
    v_cmp_ne_u32 vcc, s22, v5
    s_mov_b64 exec, -1
    s_cmp_eq_u64 vcc, 0
    s_cselect_b32 s22, 1, 0
    v_mov_b32 v4, s22
    ds_write_b32 v123, v4 offset:104
    s_mov_b64 exec, 1
    ds_add_u32 v123, v122 offset:28
    s_mov_b64 exec, -1
L_aa_wr_127:
    s_lshl_b32 s22, s25, 10
    s_add_u32 s22, s22, s28
    buffer_load_dwordx4 v[128:131], v1, s[8:11], s22 offen
    s_add_u32 s22, s22, 4290772992
    buffer_load_dwordx4 v[128:131], v1, s[8:11], s22 offen
    s_lshl_b32 s22, s18, 12
    s_lshl_b32 s23, s19, 10
    s_add_u32 s22, s22, s23
    s_add_u32 s22, s22, 3407872
    buffer_load_dwordx4 v[128:131], v1, s[8:11], s22 offen
    s_branch L_aa_warm_ret
L_aa_wrdy:
L_cw_130:
    ds_read_b32 v119, v123 offset:28
    s_waitcnt lgkmcnt(0)
    v_readfirstlane_b32 s22, v119
    s_nop 0
    s_cmp_lt_u32 s22, 5
    s_cbranch_scc1 L_cw_130
    ds_read_b32 v119, v123 offset:104
    s_waitcnt lgkmcnt(0)
    v_readfirstlane_b32 s56, v119
    s_branch L_aa_wrdy_ret
L_ts_67:
    buffer_store_dwordx4 v[8:11], v1, s[8:11], s26 offen sc0 sc1
    buffer_store_dwordx4 v[12:15], v1, s[8:11], s26 offen offset:1024 sc0 sc1
    s_branch L_ts_68
L_ts_69:
    buffer_store_dword v48, v6, s[8:11], s27 offen sc0 sc1
    s_mov_b64 exec, s[44:45]
    s_waitcnt vmcnt(1)
    buffer_store_dword v119, v118, s[8:11], s37 offen sc0 sc1
    s_waitcnt vmcnt(1)
    buffer_store_dword v119, v118, s[8:11], s37 offen offset:16 sc0 sc1
    s_mov_b64 exec, -1
    s_branch L_ts_70
L_ts_111:
    buffer_store_dwordx4 v[80:83], v1, s[8:11], s28 offen sc0 sc1
    buffer_store_dwordx4 v[96:99], v1, s[8:11], s29 offen sc0 sc1
    s_waitcnt vmcnt(0)
    s_mov_b64 exec, s[44:45]
    buffer_store_dword v5, v4, s[8:11], s37 offen sc0 sc1
    s_mov_b64 exec, -1
    s_branch L_ts_112
L_ab_slow:
    s_getpc_b64 s[32:33]
L_pc_131:
    s_add_u32 s32, s32, L_slow-L_pc_131
    s_addc_u32 s33, s33, 0
    s_add_u32 s24, s42, 73728
    s_mov_b32 s25, -8192
    s_lshl_b32 s26, s16, 1
    s_add_u32 s26, s26, 1
    s_min_u32 s26, s26, 8
    s_mov_b32 s27, -1
    v_mov_b32 v28, v20
    v_mov_b32 v29, v21
    v_mov_b32 v30, v22
    v_mov_b32 v31, v23
    s_swappc_b64 s[34:35], s[32:33]
    v_mov_b32 v96, v80
    v_mov_b32 v97, v81
    v_mov_b32 v98, v82
    v_mov_b32 v99, v83
    v_mov_b32 v100, v84
    v_mov_b32 v101, v85
    v_mov_b32 v102, v86
    v_mov_b32 v103, v87
    v_mov_b32 v104, v88
    s_add_u32 s24, s42, 65536
    s_mov_b32 s25, -8192
    s_lshl_b32 s26, s16, 1
    s_add_u32 s26, s26, 0
    s_min_u32 s26, s26, 8
    s_mov_b32 s27, -1
    v_mov_b32 v28, v16
    v_mov_b32 v29, v17
    v_mov_b32 v30, v18
    v_mov_b32 v31, v19
    s_swappc_b64 s[34:35], s[32:33]
    s_branch L_ab_store
L_ab_mid_88:
    s_sub_u32 s22, 3, s27
    s_lshl_b32 s22, s22, 13
    v_add_u32 v113, s22, v113
    v_add_u32 v114, s22, v114
    s_branch L_ab_p2_87
L_ab_exit0:
    s_cmp_lg_u32 s25, 0
    s_cbranch_scc1 L_ab_wkv_132
    buffer_load_dwordx4 v[208:211], v1, s[8:11], s53 offen offset:0 sc1
    buffer_load_dwordx4 v[212:215], v1, s[8:11], s53 offen offset:1024 sc1
    buffer_load_dwordx4 v[216:219], v1, s[8:11], s53 offen offset:2048 sc1
    buffer_load_dwordx4 v[220:223], v1, s[8:11], s53 offen offset:3072 sc1
    buffer_load_dwordx4 v[224:227], v1, s[8:11], s54 offen offset:0 sc1
    buffer_load_dwordx4 v[228:231], v1, s[8:11], s54 offen offset:1024 sc1
    buffer_load_dwordx4 v[232:235], v1, s[8:11], s54 offen offset:2048 sc1
    buffer_load_dwordx4 v[236:239], v1, s[8:11], s54 offen offset:3072 sc1
    buffer_load_dwordx4 v[240:243], v1, s[8:11], s55 offen offset:0 sc1
    buffer_load_dwordx4 v[244:247], v1, s[8:11], s55 offen offset:1024 sc1
    buffer_load_dwordx4 v[248:251], v1, s[8:11], s55 offen offset:2048 sc1
    buffer_load_dwordx4 v[252:255], v1, s[8:11], s55 offen offset:3072 sc1
    s_lshr_b32 s22, s19, 1
    s_or_b32 s22, s22, s20
    s_cmp_lg_u32 s22, 0
    s_cbranch_scc1 L_ab_wkv_132
    s_lshl_b32 s23, s46, 13
    s_add_u32 s22, s23, 524288
    s_add_u32 s23, s23, 114688
    s_mov_b32 m0, s23
    s_nop 0
    buffer_load_dwordx4 v1, s[8:11], s22 offen offset:0 sc1 lds
    buffer_load_dwordx4 v1, s[8:11], s22 offen offset:1024 sc1 lds
    buffer_load_dwordx4 v1, s[8:11], s22 offen offset:2048 sc1 lds
    buffer_load_dwordx4 v1, s[8:11], s22 offen offset:3072 sc1 lds
    s_add_u32 s22, s22, 4096
    s_add_u32 s23, s23, 4096
    s_mov_b32 m0, s23
    s_nop 0
    buffer_load_dwordx4 v1, s[8:11], s22 offen offset:0 sc1 lds
    buffer_load_dwordx4 v1, s[8:11], s22 offen offset:1024 sc1 lds
    buffer_load_dwordx4 v1, s[8:11], s22 offen offset:2048 sc1 lds
    buffer_load_dwordx4 v1, s[8:11], s22 offen offset:3072 sc1 lds
L_ab_wkv_132:
    s_cbranch_vccz L_ab_pf_133
    buffer_load_dwordx4 v[128:131], v1, s[8:11], s48 offen offset:0 sc1
    buffer_load_dwordx4 v[132:135], v1, s[8:11], s48 offen offset:1024 sc1
    buffer_load_dwordx4 v[136:139], v1, s[8:11], s48 offen offset:2048 sc1
    buffer_load_dwordx4 v[140:143], v1, s[8:11], s48 offen offset:3072 sc1
    buffer_load_dwordx4 v[144:147], v1, s[8:11], s49 offen offset:0 sc1
    buffer_load_dwordx4 v[148:151], v1, s[8:11], s49 offen offset:1024 sc1
    buffer_load_dwordx4 v[152:155], v1, s[8:11], s49 offen offset:2048 sc1
    buffer_load_dwordx4 v[156:159], v1, s[8:11], s49 offen offset:3072 sc1
    buffer_load_dwordx4 v[160:163], v1, s[8:11], s50 offen offset:0 sc1
    buffer_load_dwordx4 v[164:167], v1, s[8:11], s50 offen offset:1024 sc1
    buffer_load_dwordx4 v[168:171], v1, s[8:11], s50 offen offset:2048 sc1
    buffer_load_dwordx4 v[172:175], v1, s[8:11], s50 offen offset:3072 sc1
    buffer_load_dwordx4 v[176:179], v1, s[8:11], s51 offen offset:0 sc1
    buffer_load_dwordx4 v[180:183], v1, s[8:11], s51 offen offset:1024 sc1
    buffer_load_dwordx4 v[184:187], v1, s[8:11], s51 offen offset:2048 sc1
    buffer_load_dwordx4 v[188:191], v1, s[8:11], s51 offen offset:3072 sc1
L_ab_pf_133:
    s_branch L_ab_fin
L_ab_exit1:
    v_smfmac_f32_32x32x32_bf16 v[80:95], v[36:39], v[56:63], v112
    s_cbranch_vccz L_ab_pf_134
    buffer_load_dwordx4 v[172:175], v1, s[8:11], s50 offen offset:3072 sc1
    buffer_load_dwordx4 v[176:179], v1, s[8:11], s51 offen offset:0 sc1
    buffer_load_dwordx4 v[180:183], v1, s[8:11], s51 offen offset:1024 sc1
    buffer_load_dwordx4 v[184:187], v1, s[8:11], s51 offen offset:2048 sc1
    buffer_load_dwordx4 v[188:191], v1, s[8:11], s51 offen offset:3072 sc1
L_ab_pf_134:
    s_branch L_ab_fin
L_ab_exit2:
    v_smfmac_f32_32x32x32_bf16 v[80:95], v[44:47], v[56:63], v112
    s_branch L_ab_fin
L_ts_117:
    buffer_store_dwordx4 v[8:11], v1, s[8:11], s26 offen sc0 sc1
    buffer_store_dwordx4 v[12:15], v1, s[8:11], s26 offen offset:1024 sc0 sc1
    s_branch L_ts_118
L_ts_119:
    buffer_store_dword v48, v6, s[8:11], s27 offen sc0 sc1
    s_mov_b64 exec, s[44:45]
    s_waitcnt vmcnt(1)
    buffer_store_dword v119, v118, s[8:11], s37 offen sc0 sc1
    s_waitcnt vmcnt(1)
    buffer_store_dword v119, v118, s[8:11], s37 offen offset:16 sc0 sc1
    s_mov_b64 exec, -1
    s_branch L_ts_120
L_slow:
    s_mov_b32 s30, 0x110000
    s_mov_b32 s31, 0x110000
    v_mov_b32 v32, 0x3f803f80
    v_cndmask_b32 v32, 0, v32, s[30:31]
    v_mov_b32 v33, v32
    v_mov_b32 v34, v32
    v_mov_b32 v35, v32
    v_mov_b32 v36, v32
    v_mov_b32 v37, v32
    v_mov_b32 v38, v32
    v_mov_b32 v39, v32
    s_mov_b32 s30, 0xffff
    s_mov_b32 s31, 0xffff
    v_and_b32 v114, 15, v2
    v_lshl_add_u32 v114, v3, 4, v114
    v_lshlrev_b32 v114, 4, v114
    v_lshlrev_b32 v117, 3, v3
    v_sub_u32 v117, v2, v117
    v_mov_b32 v116, 0xf149f2ca
    s_mov_b32 s23, 0
    s_mov_b32 s22, s24
L_slow_0:
    buffer_load_dwordx4 v[24:27], v1, s[8:11], s22 offen sc1
    s_mov_b64 exec, s[30:31]
    buffer_load_dwordx4 v[32:35], v114, s[8:11], s22 offen offset:1024 sc1
    buffer_load_dwordx4 v[36:39], v114, s[8:11], s22 offen offset:1536 sc1
    s_mov_b64 exec, -1
    s_add_u32 s22, s22, s25
    s_cmp_eq_u32 s23, 0
    s_cselect_b32 s40, 0xf149f2ca, 0
    s_cmp_eq_u32 s23, 8
    s_cselect_b32 s41, 0xf149f2ca, 0
    s_and_b32 s40, s40, s27
    s_and_b32 s41, s41, s27
    v_mov_b32 v118, s40
    v_mov_b32 v119, s41
    v_cmp_le_i32 vcc, 0, v117
    s_nop 1
    v_cndmask_b32 v64, v118, v119, vcc
    v_cmp_le_i32 vcc, 1, v117
    s_nop 1
    v_cndmask_b32 v65, v118, v119, vcc
    v_cmp_le_i32 vcc, 2, v117
    s_nop 1
    v_cndmask_b32 v66, v118, v119, vcc
    v_cmp_le_i32 vcc, 3, v117
    s_nop 1
    v_cndmask_b32 v67, v118, v119, vcc
    v_cmp_le_i32 vcc, 4, v117
    s_nop 1
    v_cndmask_b32 v68, v118, v119, vcc
    v_cmp_le_i32 vcc, 5, v117
    s_nop 1
    v_cndmask_b32 v69, v118, v119, vcc
    v_cmp_le_i32 vcc, 6, v117
    s_nop 1
    v_cndmask_b32 v70, v118, v119, vcc
    v_cmp_le_i32 vcc, 7, v117
    s_nop 1
    v_cndmask_b32 v71, v118, v119, vcc
    v_cmp_le_i32 vcc, 16, v117
    s_nop 1
    v_cndmask_b32 v72, v118, v119, vcc
    v_cmp_le_i32 vcc, 17, v117
    s_nop 1
    v_cndmask_b32 v73, v118, v119, vcc
    v_cmp_le_i32 vcc, 18, v117
    s_nop 1
    v_cndmask_b32 v74, v118, v119, vcc
    v_cmp_le_i32 vcc, 19, v117
    s_nop 1
    v_cndmask_b32 v75, v118, v119, vcc
    v_cmp_le_i32 vcc, 20, v117
    s_nop 1
    v_cndmask_b32 v76, v118, v119, vcc
    v_cmp_le_i32 vcc, 21, v117
    s_nop 1
    v_cndmask_b32 v77, v118, v119, vcc
    v_cmp_le_i32 vcc, 22, v117
    s_nop 1
    v_cndmask_b32 v78, v118, v119, vcc
    v_cmp_le_i32 vcc, 23, v117
    s_nop 1
    v_cndmask_b32 v79, v118, v119, vcc
    s_waitcnt vmcnt(0)
    s_nop 1
    v_mfma_f32_32x32x16_bf16 v[48:63], v[24:27], v[28:31], v[64:79]
    s_nop 12
    v_max3_f32 v116, v48, v49, v116
    v_max3_f32 v116, v50, v51, v116
    v_max3_f32 v116, v52, v53, v116
    v_max3_f32 v116, v54, v55, v116
    v_max3_f32 v116, v56, v57, v116
    v_max3_f32 v116, v58, v59, v116
    v_max3_f32 v116, v60, v61, v116
    v_max3_f32 v116, v62, v63, v116
    s_add_u32 s23, s23, 1
    s_cmp_le_u32 s23, s26
    s_cbranch_scc1 L_slow_0
    v_mov_b32 v118, v116
    s_nop 1
    v_permlane32_swap_b32 v116, v118
    v_max_f32 v116, v116, v118
    v_mov_b32 v80, 0
    v_mov_b32 v81, 0
    v_mov_b32 v82, 0
    v_mov_b32 v83, 0
    v_mov_b32 v84, 0
    v_mov_b32 v85, 0
    v_mov_b32 v86, 0
    v_mov_b32 v87, 0
    v_mov_b32 v88, 0
    v_mov_b32 v89, 0
    v_mov_b32 v90, 0
    v_mov_b32 v91, 0
    v_mov_b32 v92, 0
    v_mov_b32 v93, 0
    v_mov_b32 v94, 0
    v_mov_b32 v95, 0
    s_mov_b32 s23, 0
    s_mov_b32 s22, s24
L_slow_1:
    buffer_load_dwordx4 v[24:27], v1, s[8:11], s22 offen sc1
    s_mov_b64 exec, s[30:31]
    buffer_load_dwordx4 v[32:35], v114, s[8:11], s22 offen offset:1024 sc1
    buffer_load_dwordx4 v[36:39], v114, s[8:11], s22 offen offset:1536 sc1
    s_mov_b64 exec, -1
    s_add_u32 s22, s22, s25
    s_cmp_eq_u32 s23, 0
    s_cselect_b32 s40, 0xf149f2ca, 0
    s_cmp_eq_u32 s23, 8
    s_cselect_b32 s41, 0xf149f2ca, 0
    s_and_b32 s40, s40, s27
    s_and_b32 s41, s41, s27
    v_mov_b32 v118, s40
    v_mov_b32 v119, s41
    v_cmp_le_i32 vcc, 0, v117
    s_nop 1
    v_cndmask_b32 v64, v118, v119, vcc
    v_cmp_le_i32 vcc, 1, v117
    s_nop 1
    v_cndmask_b32 v65, v118, v119, vcc
    v_cmp_le_i32 vcc, 2, v117
    s_nop 1
    v_cndmask_b32 v66, v118, v119, vcc
    v_cmp_le_i32 vcc, 3, v117
    s_nop 1
    v_cndmask_b32 v67, v118, v119, vcc
    v_cmp_le_i32 vcc, 4, v117
    s_nop 1
    v_cndmask_b32 v68, v118, v119, vcc
    v_cmp_le_i32 vcc, 5, v117
    s_nop 1
    v_cndmask_b32 v69, v118, v119, vcc
    v_cmp_le_i32 vcc, 6, v117
    s_nop 1
    v_cndmask_b32 v70, v118, v119, vcc
    v_cmp_le_i32 vcc, 7, v117
    s_nop 1
    v_cndmask_b32 v71, v118, v119, vcc
    v_cmp_le_i32 vcc, 16, v117
    s_nop 1
    v_cndmask_b32 v72, v118, v119, vcc
    v_cmp_le_i32 vcc, 17, v117
    s_nop 1
    v_cndmask_b32 v73, v118, v119, vcc
    v_cmp_le_i32 vcc, 18, v117
    s_nop 1
    v_cndmask_b32 v74, v118, v119, vcc
    v_cmp_le_i32 vcc, 19, v117
    s_nop 1
    v_cndmask_b32 v75, v118, v119, vcc
    v_cmp_le_i32 vcc, 20, v117
    s_nop 1
    v_cndmask_b32 v76, v118, v119, vcc
    v_cmp_le_i32 vcc, 21, v117
    s_nop 1
    v_cndmask_b32 v77, v118, v119, vcc
    v_cmp_le_i32 vcc, 22, v117
    s_nop 1
    v_cndmask_b32 v78, v118, v119, vcc
    v_cmp_le_i32 vcc, 23, v117
    s_nop 1
    v_cndmask_b32 v79, v118, v119, vcc
    s_waitcnt vmcnt(0)
    s_nop 1
    v_mfma_f32_32x32x16_bf16 v[48:63], v[24:27], v[28:31], v[64:79]
    s_nop 12
    v_sub_f32 v48, v48, v116
    v_sub_f32 v49, v49, v116
    v_sub_f32 v50, v50, v116
    v_sub_f32 v51, v51, v116
    v_sub_f32 v52, v52, v116
    v_sub_f32 v53, v53, v116
    v_sub_f32 v54, v54, v116
    v_sub_f32 v55, v55, v116
    v_sub_f32 v56, v56, v116
    v_sub_f32 v57, v57, v116
    v_sub_f32 v58, v58, v116
    v_sub_f32 v59, v59, v116
    v_sub_f32 v60, v60, v116
    v_sub_f32 v61, v61, v116
    v_sub_f32 v62, v62, v116
    v_sub_f32 v63, v63, v116
    v_exp_f32 v48, v48
    v_exp_f32 v49, v49
    v_exp_f32 v50, v50
    v_exp_f32 v51, v51
    v_exp_f32 v52, v52
    v_exp_f32 v53, v53
    v_exp_f32 v54, v54
    v_exp_f32 v55, v55
    v_exp_f32 v56, v56
    v_exp_f32 v57, v57
    v_exp_f32 v58, v58
    v_exp_f32 v59, v59
    v_exp_f32 v60, v60
    v_exp_f32 v61, v61
    v_exp_f32 v62, v62
    v_exp_f32 v63, v63
    s_nop 1
    v_smfmac_f32_32x32x32_bf16 v[80:95], v[32:35], v[48:55], v112
    v_smfmac_f32_32x32x32_bf16 v[80:95], v[36:39], v[56:63], v112
    s_nop 12
    s_add_u32 s23, s23, 1
    s_cmp_le_u32 s23, s26
    s_cbranch_scc1 L_slow_1
    s_setpc_b64 s[34:35]
L_text_end:
.section .rodata,"a"
.p2align 6
.amdhsa_kernel interleave_layers__grouped_kv_mqa__sliding_block__prompt_kernel
  .amdhsa_next_free_vgpr 256
  .amdhsa_next_free_sgpr 84
  .amdhsa_accum_offset 256
  .amdhsa_group_segment_fixed_size 0
  .amdhsa_kernarg_size 88
  .amdhsa_user_sgpr_count 2
  .amdhsa_user_sgpr_kernarg_segment_ptr 1
  .amdhsa_system_sgpr_workgroup_id_x 1
.end_amdhsa_kernel
```
